```python
import torch

def _softmax(x, axis=-1):
    return torch.softmax(x, dim=axis)
def _gelu(x):
    return torch.nn.functional.gelu(x, approximate="tanh")
def _silu(x):
    return torch.nn.functional.silu(x)
def _sigmoid(x):
    return torch.sigmoid(x)
def _layernorm(x, axis=-1, eps=1e-5):
    m = x.mean(dim=axis, keepdim=True)
    v = x.var(dim=axis, keepdim=True, unbiased=False)
    return (x - m) / torch.sqrt(v + eps)
def _scatter_add(tgt, idx, src, axis=0):
    return tgt.clone().index_add_(axis, idx, src)
def _segment_sum(src, seg, n):
    out = torch.zeros((n,) + src.shape[1:], dtype=src.dtype)
    return out.index_add_(0, seg, src)
def _pad(x, pw):
    flat = tuple(v for pair in reversed(pw) for v in pair)
    return torch.nn.functional.pad(x, flat)

kernel_name = 'parallel_sum__softmax_full_mha__glu_gated_reglu__prompt'

def setup_inputs():

    _w = (lambda a: (lambda t: t.to(torch.bfloat16) if t.is_floating_point() else t)(torch.as_tensor(a)))
    def _A_setup():
        B, S, D = 1, 2048, 640
        return {
            "x": _w((lambda *s: torch.randn(*s, dtype=torch.bfloat16) * 0.05)(B, S, D)),
            "wqkv": _w((lambda *s: torch.randn(*s, dtype=torch.bfloat16) * 0.05)(D, 3 * D)),
            "wo": _w((lambda *s: torch.randn(*s, dtype=torch.bfloat16) * 0.05)(D, D)),
        }
    _A_in = _A_setup()

    def _B_setup():
        B, S, D, F = 1, 2048, 640, 1536
        return {
            "x": _w((lambda *s: torch.randn(*s, dtype=torch.bfloat16) * 0.05)(B, S, D)),
            "W_gate": _w((lambda *s: torch.randn(*s, dtype=torch.bfloat16) * 0.4)(D, F) * (2.0 / D) ** 0.5),
            "W_up": _w((lambda *s: torch.randn(*s, dtype=torch.bfloat16) * 0.4)(D, F) * (2.0 / D) ** 0.5),
            "W_down": _w((lambda *s: torch.randn(*s, dtype=torch.bfloat16) * 0.4)(F, D) * (1.0 / F) ** 0.5),
        }
    _B_in = _B_setup()

    return {
        "A_x": _A_in["x"],
        "A_wqkv": _A_in["wqkv"],
        "A_wo": _A_in["wo"],
        "B_x": _B_in["x"],
        "B_W_gate": _B_in["W_gate"],
        "B_W_up": _B_in["W_up"],
        "B_W_down": _B_in["W_down"],
    }

def reference(A_x, A_wqkv, A_wo, B_x, B_W_gate, B_W_up, B_W_down):
    def _A_ref(x, wqkv, wo):
        B, S, D = x.shape
        H = 32; Dh = D // H
        qkv = (lambda x, *d: x.permute(*d))((x @ wqkv).reshape(B, S, 3, H, Dh), 2, 0, 3, 1, 4)
        q, k, v = qkv[0], qkv[1], qkv[2]
        scale = Dh ** -0.5
        scores = torch.einsum("bhqd,bhkd->bhqk", q, k) * scale
        p = _softmax(scores, axis=-1)
        o = torch.einsum("bhqk,bhkd->bhqd", p, v)
        return (lambda x, *d: x.permute(*d))(o, 0, 2, 1, 3).reshape(B, S, D) @ wo

    def _B_ref(x, W_gate, W_up, W_down):
        gate = torch.einsum("bsd,df->bsf", x, W_gate)
        up = torch.einsum("bsd,df->bsf", x, W_up)
        gate = gate * (lambda x, dt: x.to(dt))(gate > 0, gate.dtype)
        h = gate * up
        return torch.einsum("bsf,fd->bsd", h, W_down)

    x = A_x
    xn = _layernorm(x, axis=-1)
    return x + _A_ref(xn, A_wqkv, A_wo) + _B_ref(xn, B_W_gate, B_W_up, B_W_down)
```

```asm
; @launch grid=(256,1,1) block=(512,1,1) lds=139456
.amdgcn_target "amdgcn-amd-amdhsa--gfx950"
.text
.globl parallel_sum__softmax_full_mha__glu_gated_reglu__prompt_kernel
.p2align 8
.type parallel_sum__softmax_full_mha__glu_gated_reglu__prompt_kernel,@function
parallel_sum__softmax_full_mha__glu_gated_reglu__prompt_kernel:
    s_cmp_ge_u32 s2, 256
    s_cbranch_scc1 parallel_sum__softmax_full_mha__glu_gated_reglu__prompt_kernel_end
    s_load_dwordx4 s[4:7], s[0:1], 0
    s_load_dwordx4 s[52:55], s[0:1], 32
    s_load_dwordx2 s[60:61], s[0:1], 72
    s_load_dwordx2 s[24:25], s[0:1], 64
    v_lshrrev_b32 v2, 6, v0
    v_and_b32 v5, 255, v0
    v_and_b32 v0, 63, v0
    v_readfirstlane_b32 s3, v2
    v_lshlrev_b32 v1, 4, v0
    s_and_b32 s33, s2, 7
    s_lshr_b32 s34, s2, 3
    s_and_b32 s28, s33, 1
    s_lshl_b32 s28, s28, 3
    s_and_b32 s29, s34, 7
    s_add_u32 s28, s28, s29
    s_lshr_b32 s29, s33, 1
    s_lshl_b32 s29, s29, 2
    s_lshr_b32 s34, s34, 3
    s_add_u32 s29, s29, s34
    s_and_b32 s32, s3, 3
    s_lshr_b32 s30, s32, 1
    s_and_b32 s31, s32, 1
    s_cmp_lt_u32 s3, 4
    s_cbranch_scc1 parallel_sum__softmax_full_mha__glu_gated_reglu__prompt_kernel_rd
    v_lshrrev_b32 v2, 3, v0
    v_lshrrev_b32 v3, 4, v0
    v_xor_b32 v3, v3, v0
    v_and_b32 v3, 7, v3
    v_mul_u32_u24 v2, 1280, v2
    v_lshl_add_u32 v31, v3, 4, v2
    v_xor_b32 v3, 4, v3
    v_lshl_add_u32 v32, v3, 4, v2
    v_add_u32 v33, 18432, v31
    v_add_u32 v34, 27648, v32
    v_add_u32 v32, 9216, v32
    s_lshl_b32 s38, s28, 7
    s_lshl_b32 s33, s32, 5
    s_add_u32 s38, s38, s33
    s_mul_i32 s38, s38, 1280
    s_lshl_b32 s47, s32, 12
    s_add_u32 s47, s47, 90240
    s_mov_b32 s10, 2621440
    s_mov_b32 s11, 0x20000
    s_mov_b32 s15, 0x20000
    s_mov_b32 s19, 0x20000
    s_mov_b32 s23, 0x20000
    s_mov_b32 s22, 2457600
    s_mov_b32 s14, 1966080
    s_mov_b32 s42, 0
    v_lshrrev_b32 v2, 4, v0
    v_lshlrev_b32 v3, 2, v2
    v_xor_b32 v3, v3, v0
    v_and_b32 v3, 15, v3
    v_mul_u32_u24 v2, 3840, v2
    v_lshl_add_u32 v26, v3, 4, v2
    v_add_u32 v27, 14336, v26
    v_add_u32 v2, 0, v0
    v_mul_u32_u24 v3, 5462, v2
    v_lshrrev_b32 v3, 16, v3
    v_mul_u32_u24 v3, 2880, v3
    v_lshl_add_u32 v28, v2, 4, v3
    v_add_u32 v2, 64, v0
    v_mul_u32_u24 v3, 5462, v2
    v_lshrrev_b32 v3, 16, v3
    v_mul_u32_u24 v3, 2880, v3
    v_lshl_add_u32 v29, v2, 4, v3
    v_subrev_u32 v29, 1024, v29
    v_add_u32 v2, 128, v0
    v_mul_u32_u24 v3, 5462, v2
    v_lshrrev_b32 v3, 16, v3
    v_mul_u32_u24 v3, 2880, v3
    v_lshl_add_u32 v30, v2, 4, v3
    v_subrev_u32 v30, 2048, v30
    s_mul_i32 s37, s32, 30720
    s_lshl_b32 s33, s29, 8
    s_add_u32 s37, s37, s33
    s_mul_i32 s35, s31, 49152
    s_mul_i32 s33, s29, 192
    s_add_u32 s35, s35, s33
    s_lshl_b32 s36, s32, 11
    s_mul_i32 s40, s31, 3072
    s_mul_i32 s33, s30, 6176
    s_add_u32 s40, s40, s33
    s_add_u32 s40, s40, 8192
    s_cmp_eq_u32 s29, 15
    s_cselect_b32 s22, 0, s22
    s_waitcnt lgkmcnt(0)
    s_cmp_eq_u32 s30, 0
    s_cselect_b32 s12, s52, s54
    s_cselect_b32 s13, s53, s55
    s_mov_b32 s20, s6
    s_mov_b32 s21, s7
    s_mov_b32 s8, s4
    s_mov_b32 s9, s5
    s_cmp_ge_u32 s42, 10
    s_cselect_b32 s10, 0, s10
    s_add_u32 m0, s47, 0
    s_add_u32 s42, s42, 1
    buffer_load_dwordx4 v31, s[8:11], s38 offen lds
    buffer_load_dwordx4 v32, s[8:11], s38 offen offset:1024 lds
    buffer_load_dwordx4 v33, s[8:11], s38 offen offset:2048 lds
    buffer_load_dwordx4 v34, s[8:11], s38 offen offset:3072 lds
    s_add_u32 s38, s38, 128
    s_add_u32 m0, s36, 8192
    s_nop 0
    buffer_load_dwordx4 v26, s[20:23], s37 offen lds
    buffer_load_dwordx4 v27, s[20:23], s37 offen offset:1024 lds
    s_add_u32 m0, s40, 8192
    s_add_u32 s37, s37, 122880
    buffer_load_dwordx4 v28, s[12:15], s35 offen lds
    buffer_load_dwordx4 v29, s[12:15], s35 offen offset:1024 lds
    buffer_load_dwordx4 v30, s[12:15], s35 offen offset:2048 lds
    s_add_u32 s35, s35, 98304
    s_add_u32 m0, s36, 28704
    s_nop 0
    buffer_load_dwordx4 v26, s[20:23], s37 offen lds
    buffer_load_dwordx4 v27, s[20:23], s37 offen offset:1024 lds
    s_add_u32 m0, s40, 28704
    s_add_u32 s37, s37, 122880
    buffer_load_dwordx4 v28, s[12:15], s35 offen lds
    buffer_load_dwordx4 v29, s[12:15], s35 offen offset:1024 lds
    buffer_load_dwordx4 v30, s[12:15], s35 offen offset:2048 lds
    s_add_u32 s35, s35, 98304
parallel_sum__softmax_full_mha__glu_gated_reglu__prompt_kernel_rd:
    s_mul_i32 s48, s29, 13108
    s_lshr_b32 s48, s48, 16
    s_mul_i32 s33, s48, 5
    s_sub_u32 s39, s29, s33
    s_cmp_ge_u32 s3, 4
    s_cbranch_scc1 parallel_sum__softmax_full_mha__glu_gated_reglu__prompt_kernel_nopf
    s_getpc_b64 s[56:57]
.Lpc_parallel_sum__softmax_full_mha__glu_gated_reglu__prompt_kernel_nopf_134:
    s_add_u32 s56, s56, parallel_sum__softmax_full_mha__glu_gated_reglu__prompt_kernel_nopf-.Lpc_parallel_sum__softmax_full_mha__glu_gated_reglu__prompt_kernel_nopf_134
    s_addc_u32 s57, s57, (parallel_sum__softmax_full_mha__glu_gated_reglu__prompt_kernel_nopf-.Lpc_parallel_sum__softmax_full_mha__glu_gated_reglu__prompt_kernel_nopf_134)>>32
    s_mov_b32 s58, parallel_sum__softmax_full_mha__glu_gated_reglu__prompt_kernel_end-parallel_sum__softmax_full_mha__glu_gated_reglu__prompt_kernel_nopf
    s_mov_b32 s59, 0x20000
    s_lshl_b32 s33, s32, 13
    v_lshlrev_b32 v249, 3, v1
    buffer_load_dword v248, v249, s[56:59], s33 offen
parallel_sum__softmax_full_mha__glu_gated_reglu__prompt_kernel_nopf:
    v_and_b32 v6, 31, v0
    v_lshrrev_b32 v7, 5, v0
    s_lshl_b32 s33, s31, 1
    s_cmp_ge_u32 s3, 4
    s_cselect_b32 s33, s32, s33
    s_cselect_b32 s34, s31, 0
    s_lshl_b32 s33, s33, 12
    s_add_u32 s33, s33, 90240
    v_bfe_u32 v3, v0, 1, 3
    v_xor_b32 v3, v3, v7
    v_lshlrev_b32 v2, 7, v6
    v_add_u32 v2, s33, v2
    v_xor_b32 v8, 0, v3
    v_lshl_add_u32 v12, v8, 4, v2
    v_xor_b32 v8, 2, v3
    v_lshl_add_u32 v13, v8, 4, v2
    v_xor_b32 v8, 4, v3
    v_lshl_add_u32 v14, v8, 4, v2
    v_xor_b32 v8, 6, v3
    v_lshl_add_u32 v15, v8, 4, v2
    v_bfe_u32 v2, v0, 2, 2
    v_lshl_add_u32 v3, v7, 3, v2
    s_lshl_b32 s34, s34, 4
    v_add_u32 v3, s34, v3
    v_and_b32 v4, 3, v0
    v_lshlrev_b32 v4, 3, v4
    v_add_u32 v4, 8192, v4
    v_bfe_u32 v8, v0, 4, 1
    v_lshlrev_b32 v9, 8, v3
    v_lshl_add_u32 v9, v8, 5, v9
    v_add_u32 v9, v9, v4
    s_lshl_b32 s33, s30, 1
    v_xor_b32 v10, s33, v2
    v_lshl_add_u32 v16, v10, 6, v9
    v_xor_b32 v10, 1, v10
    v_lshl_add_u32 v17, v10, 6, v9
    v_mul_u32_u24 v18, 192, v3
    v_mul_u32_u24 v9, 6176, v8
    v_add3_u32 v18, v18, v9, v4
    s_mul_i32 s33, s30, 96
    s_add_u32 s33, s33, 8192
    v_add_u32 v18, s33, v18
    v_add_u32 v19, 41024, v16
    v_add_u32 v20, 41024, v17
    v_add_u32 v21, 41024, v18
    s_mov_b32 s41, 5
    s_cmp_lt_u32 s3, 4
    s_cbranch_scc1 parallel_sum__softmax_full_mha__glu_gated_reglu__prompt_kernel_comp
    s_setprio 0
    s_mov_b32 s44, -1
    s_mov_b32 s45, 0
    s_mov_b32 s26, 256
    s_mov_b32 s27, 0x20000
    s_mov_b32 s62, 20512768
    s_mov_b32 s63, 0x20000
    s_or_b32 s33, s2, s32
    s_cmp_lg_u32 s33, 0
    s_cbranch_scc1 parallel_sum__softmax_full_mha__glu_gated_reglu__prompt_kernel_notag
    s_memrealtime s[50:51]
    s_waitcnt lgkmcnt(0)
    s_or_b32 s50, s50, 1
    v_mov_b32 v216, s50
    v_mov_b32 v217, s51
    v_mov_b32 v2, 0
    s_mov_b64 exec, 1
    buffer_store_dwordx2 v[216:217], v2, s[24:27], 0 offen sc1
    s_mov_b64 exec, -1
parallel_sum__softmax_full_mha__glu_gated_reglu__prompt_kernel_notag:
    v_mov_b32 v219, 139392
    v_mov_b32 v176, 0
    v_mov_b32 v177, 0
    ds_write_b64 v219, v[176:177]
    ds_write_b64 v219, v[176:177] offset:8
    s_waitcnt vmcnt(5) lgkmcnt(0)
    s_barrier
    s_add_u32 m0, s36, 49216
    s_nop 0
    buffer_load_dwordx4 v26, s[20:23], s37 offen lds
    buffer_load_dwordx4 v27, s[20:23], s37 offen offset:1024 lds
    s_add_u32 m0, s40, 49216
    s_add_u32 s37, s37, 122880
    buffer_load_dwordx4 v28, s[12:15], s35 offen lds
    buffer_load_dwordx4 v29, s[12:15], s35 offen offset:1024 lds
    buffer_load_dwordx4 v30, s[12:15], s35 offen offset:2048 lds
    s_add_u32 s35, s35, 98304
    s_cmp_ge_u32 s42, 10
    s_cselect_b32 s10, 0, s10
    s_add_u32 m0, s47, 16384
    s_add_u32 s42, s42, 1
    buffer_load_dwordx4 v31, s[8:11], s38 offen lds
    buffer_load_dwordx4 v32, s[8:11], s38 offen offset:1024 lds
    buffer_load_dwordx4 v33, s[8:11], s38 offen offset:2048 lds
    buffer_load_dwordx4 v34, s[8:11], s38 offen offset:3072 lds
    s_add_u32 s38, s38, 128
    s_add_u32 m0, s36, 69728
    s_nop 0
    buffer_load_dwordx4 v26, s[20:23], s37 offen lds
    buffer_load_dwordx4 v27, s[20:23], s37 offen offset:1024 lds
    s_add_u32 m0, s40, 69728
    s_add_u32 s37, s37, 122880
    buffer_load_dwordx4 v28, s[12:15], s35 offen lds
    buffer_load_dwordx4 v29, s[12:15], s35 offen offset:1024 lds
    buffer_load_dwordx4 v30, s[12:15], s35 offen offset:2048 lds
    s_add_u32 s35, s35, 98304
    s_waitcnt vmcnt(14) lgkmcnt(0)
    s_barrier
    s_add_u32 m0, s36, 8192
    s_nop 0
    buffer_load_dwordx4 v26, s[20:23], s37 offen lds
    buffer_load_dwordx4 v27, s[20:23], s37 offen offset:1024 lds
    s_add_u32 m0, s40, 8192
    s_add_u32 s37, s37, 122880
    buffer_load_dwordx4 v28, s[12:15], s35 offen lds
    buffer_load_dwordx4 v29, s[12:15], s35 offen offset:1024 lds
    buffer_load_dwordx4 v30, s[12:15], s35 offen offset:2048 lds
    s_add_u32 s35, s35, 98304
    s_lshl_b32 s33, s28, 7
    s_lshl_b32 s34, s29, 3
    s_add_u32 s33, s33, s34
    s_lshl_b32 s34, s32, 1
    s_add_u32 s33, s33, s34
    s_mul_i32 s43, s33, 1280
    v_mul_u32_u24 v5, 1280, v7
    v_lshl_add_u32 v5, v6, 3, v5
    buffer_load_dwordx2 v[84:85], v5, s[8:11], s43 offen offset:0
    buffer_load_dwordx2 v[86:87], v5, s[8:11], s43 offen offset:256
    buffer_load_dwordx2 v[88:89], v5, s[8:11], s43 offen offset:512
    buffer_load_dwordx2 v[90:91], v5, s[8:11], s43 offen offset:768
    buffer_load_dwordx2 v[92:93], v5, s[8:11], s43 offen offset:1024
    s_min_u32 s33, s29, 14
    s_lshl_b32 s33, s33, 8
    v_add_u32 v2, s33, v1
    s_mul_i32 s33, s29, 192
    s_sub_u32 s34, s33, 256
    v_add_u32 v3, s34, v1
    s_sub_u32 s34, s33, 448
    v_add_u32 v4, s34, v1
    v_mov_b32 v94, s54
    v_mov_b32 v95, s55
    v_mov_b32 v96, 3072
    v_cmp_gt_u32 vcc, 28, v0
    v_mov_b32 v8, s52
    v_mov_b32 v9, s53
    v_cndmask_b32 v4, v4, v3, vcc
    v_cndmask_b32 v94, v94, v8, vcc
    v_cndmask_b32 v95, v95, v9, vcc
    v_cmp_gt_u32 vcc, 16, v0
    v_mov_b32 v8, s6
    v_mov_b32 v9, s7
    v_mov_b32 v10, 3840
    v_cndmask_b32 v4, v4, v2, vcc
    v_cndmask_b32 v94, v94, v8, vcc
    v_cndmask_b32 v95, v95, v9, vcc
    v_cndmask_b32 v96, v96, v10, vcc
    s_mul_i32 s33, s28, 40
    s_mul_i32 s34, s32, 10
    s_add_u32 s33, s33, s34
    v_mul_lo_u32 v2, v96, s33
    v_add_u32 v4, v4, v2
    v_add_co_u32 v94, vcc, v94, v4
    s_nop 1
    v_addc_co_u32 v95, vcc, 0, v95, vcc
    v_mov_b32 v2, 0
    buffer_load_dwordx2 v[216:217], v2, s[24:27], 0 offen sc1
    s_mov_b32 exec_hi, 0xff
    global_load_dwordx4 v[100:103], v[94:95], off
    v_add_co_u32 v94, vcc, v94, v96
    s_nop 1
    v_addc_co_u32 v95, vcc, 0, v95, vcc
    global_load_dwordx4 v[104:107], v[94:95], off
    v_add_co_u32 v94, vcc, v94, v96
    s_nop 1
    v_addc_co_u32 v95, vcc, 0, v95, vcc
    global_load_dwordx4 v[108:111], v[94:95], off
    v_add_co_u32 v94, vcc, v94, v96
    s_nop 1
    v_addc_co_u32 v95, vcc, 0, v95, vcc
    global_load_dwordx4 v[112:115], v[94:95], off
    v_add_co_u32 v94, vcc, v94, v96
    s_nop 1
    v_addc_co_u32 v95, vcc, 0, v95, vcc
    global_load_dwordx4 v[116:119], v[94:95], off
    v_add_co_u32 v94, vcc, v94, v96
    s_nop 1
    v_addc_co_u32 v95, vcc, 0, v95, vcc
    global_load_dwordx4 v[120:123], v[94:95], off
    v_add_co_u32 v94, vcc, v94, v96
    s_nop 1
    v_addc_co_u32 v95, vcc, 0, v95, vcc
    global_load_dwordx4 v[124:127], v[94:95], off
    v_add_co_u32 v94, vcc, v94, v96
    s_nop 1
    v_addc_co_u32 v95, vcc, 0, v95, vcc
    global_load_dwordx4 v[128:131], v[94:95], off
    v_add_co_u32 v94, vcc, v94, v96
    s_nop 1
    v_addc_co_u32 v95, vcc, 0, v95, vcc
    global_load_dwordx4 v[132:135], v[94:95], off
    v_add_co_u32 v94, vcc, v94, v96
    s_nop 1
    v_addc_co_u32 v95, vcc, 0, v95, vcc
    global_load_dwordx4 v[136:139], v[94:95], off
    s_mov_b64 exec, -1
    v_subrev_u32 v2, 16, v0
    v_subrev_u32 v3, 28, v0
    v_cmp_gt_u32 vcc, 28, v0
    s_nop 1
    v_cndmask_b32 v2, v3, v2, vcc
    v_cndmask_b32 v4, 16, 0, vcc
    v_lshrrev_b32 v3, 1, v2
    v_lshl_add_u32 v4, v3, 5, v4
    v_and_b32 v2, 1, v2
    v_lshl_add_u32 v4, v2, 3, v4
    v_add_u32 v4, 128, v4
    v_lshlrev_b32 v2, 3, v0
    v_cmp_gt_u32 vcc, 16, v0
    s_nop 1
    v_cndmask_b32 v4, v4, v2, vcc
    v_lshlrev_b32 v4, 2, v4
    s_mul_i32 s33, s32, 1280
    v_add_u32 v172, s33, v4
    s_lshl_b32 s49, s32, 4
    s_waitcnt vmcnt(26) lgkmcnt(0)
    s_barrier
    s_cmp_ge_u32 s42, 10
    s_cselect_b32 s10, 0, s10
    s_add_u32 m0, s47, 0
    s_add_u32 s42, s42, 1
    buffer_load_dwordx4 v31, s[8:11], s38 offen lds
    buffer_load_dwordx4 v32, s[8:11], s38 offen offset:1024 lds
    buffer_load_dwordx4 v33, s[8:11], s38 offen offset:2048 lds
    buffer_load_dwordx4 v34, s[8:11], s38 offen offset:3072 lds
    s_add_u32 s38, s38, 128
    s_add_u32 m0, s36, 28704
    s_nop 0
    buffer_load_dwordx4 v26, s[20:23], s37 offen lds
    buffer_load_dwordx4 v27, s[20:23], s37 offen offset:1024 lds
    s_add_u32 m0, s40, 28704
    s_add_u32 s37, s37, 122880
    buffer_load_dwordx4 v28, s[12:15], s35 offen lds
    buffer_load_dwordx4 v29, s[12:15], s35 offen offset:1024 lds
    buffer_load_dwordx4 v30, s[12:15], s35 offen offset:2048 lds
    s_add_u32 s35, s35, 98304
    s_waitcnt vmcnt(30) lgkmcnt(0)
    s_barrier
    s_add_u32 m0, s36, 49216
    s_nop 0
    buffer_load_dwordx4 v26, s[20:23], s37 offen lds
    buffer_load_dwordx4 v27, s[20:23], s37 offen offset:1024 lds
    s_add_u32 m0, s40, 49216
    s_add_u32 s37, s37, 122880
    buffer_load_dwordx4 v28, s[12:15], s35 offen lds
    buffer_load_dwordx4 v29, s[12:15], s35 offen offset:1024 lds
    buffer_load_dwordx4 v30, s[12:15], s35 offen offset:2048 lds
    s_add_u32 s35, s35, 98304
    s_waitcnt vmcnt(10) lgkmcnt(0)
    s_barrier
    s_cmp_ge_u32 s42, 10
    s_cselect_b32 s10, 0, s10
    s_add_u32 m0, s47, 16384
    s_add_u32 s42, s42, 1
    buffer_load_dwordx4 v31, s[8:11], s38 offen lds
    buffer_load_dwordx4 v32, s[8:11], s38 offen offset:1024 lds
    buffer_load_dwordx4 v33, s[8:11], s38 offen offset:2048 lds
    buffer_load_dwordx4 v34, s[8:11], s38 offen offset:3072 lds
    s_add_u32 s38, s38, 128
    s_add_u32 m0, s36, 69728
    s_nop 0
    buffer_load_dwordx4 v26, s[20:23], s37 offen lds
    buffer_load_dwordx4 v27, s[20:23], s37 offen offset:1024 lds
    s_add_u32 m0, s40, 69728
    s_add_u32 s37, s37, 122880
    buffer_load_dwordx4 v28, s[12:15], s35 offen lds
    buffer_load_dwordx4 v29, s[12:15], s35 offen offset:1024 lds
    buffer_load_dwordx4 v30, s[12:15], s35 offen offset:2048 lds
    s_add_u32 s35, s35, 98304
    v_lshlrev_b32 v148, 16, v84
    v_and_b32 v149, 0xffff0000, v84
    v_lshlrev_b32 v150, 16, v85
    v_and_b32 v151, 0xffff0000, v85
    v_lshlrev_b32 v152, 16, v86
    v_and_b32 v153, 0xffff0000, v86
    v_lshlrev_b32 v154, 16, v87
    v_and_b32 v155, 0xffff0000, v87
    v_lshlrev_b32 v156, 16, v88
    v_and_b32 v157, 0xffff0000, v88
    v_lshlrev_b32 v158, 16, v89
    v_and_b32 v159, 0xffff0000, v89
    v_lshlrev_b32 v160, 16, v90
    v_and_b32 v161, 0xffff0000, v90
    v_lshlrev_b32 v162, 16, v91
    v_and_b32 v163, 0xffff0000, v91
    v_lshlrev_b32 v164, 16, v92
    v_and_b32 v165, 0xffff0000, v92
    v_lshlrev_b32 v166, 16, v93
    v_and_b32 v167, 0xffff0000, v93
    v_add_f32 v168, v148, v149
    v_add_f32 v169, v150, v151
    v_add_f32 v168, v168, v152
    v_add_f32 v169, v169, v153
    v_add_f32 v168, v168, v154
    v_add_f32 v169, v169, v155
    v_add_f32 v168, v168, v156
    v_add_f32 v169, v169, v157
    v_add_f32 v168, v168, v158
    v_add_f32 v169, v169, v159
    v_add_f32 v168, v168, v160
    v_add_f32 v169, v169, v161
    v_add_f32 v168, v168, v162
    v_add_f32 v169, v169, v163
    v_add_f32 v168, v168, v164
    v_add_f32 v169, v169, v165
    v_add_f32 v168, v168, v166
    v_add_f32 v169, v169, v167
    v_add_f32 v168, v168, v169
    s_nop 1
    v_add_f32_dpp v168, v168, v168 quad_perm:[1,0,3,2] row_mask:0xf bank_mask:0xf
    s_nop 1
    v_add_f32_dpp v168, v168, v168 quad_perm:[2,3,0,1] row_mask:0xf bank_mask:0xf
    s_nop 1
    v_add_f32_dpp v168, v168, v168 row_half_mirror row_mask:0xf bank_mask:0xf
    s_nop 1
    v_add_f32_dpp v168, v168, v168 row_mirror row_mask:0xf bank_mask:0xf
    v_mov_b32 v169, v168
    s_nop 1
    v_permlane16_swap_b32 v169, v168
    v_add_f32 v168, v168, v169
    v_mul_f32 v168, 0xbacccccd, v168
    v_add_f32 v148, v168, v148
    v_add_f32 v149, v168, v149
    v_add_f32 v150, v168, v150
    v_add_f32 v151, v168, v151
    v_add_f32 v152, v168, v152
    v_add_f32 v153, v168, v153
    v_add_f32 v154, v168, v154
    v_add_f32 v155, v168, v155
    v_add_f32 v156, v168, v156
    v_add_f32 v157, v168, v157
    v_add_f32 v158, v168, v158
    v_add_f32 v159, v168, v159
    v_add_f32 v160, v168, v160
    v_add_f32 v161, v168, v161
    v_add_f32 v162, v168, v162
    v_add_f32 v163, v168, v163
    v_add_f32 v164, v168, v164
    v_add_f32 v165, v168, v165
    v_add_f32 v166, v168, v166
    v_add_f32 v167, v168, v167
    v_mul_f32 v170, v148, v148
    v_mul_f32 v171, v149, v149
    v_fmac_f32 v170, v150, v150
    v_fmac_f32 v171, v151, v151
    v_fmac_f32 v170, v152, v152
    v_fmac_f32 v171, v153, v153
    v_fmac_f32 v170, v154, v154
    v_fmac_f32 v171, v155, v155
    v_fmac_f32 v170, v156, v156
    v_fmac_f32 v171, v157, v157
    v_fmac_f32 v170, v158, v158
    v_fmac_f32 v171, v159, v159
    v_fmac_f32 v170, v160, v160
    v_fmac_f32 v171, v161, v161
    v_fmac_f32 v170, v162, v162
    v_fmac_f32 v171, v163, v163
    v_fmac_f32 v170, v164, v164
    v_fmac_f32 v171, v165, v165
    v_fmac_f32 v170, v166, v166
    v_fmac_f32 v171, v167, v167
    v_add_f32 v170, v170, v171
    s_nop 1
    v_add_f32_dpp v170, v170, v170 quad_perm:[1,0,3,2] row_mask:0xf bank_mask:0xf
    s_nop 1
    v_add_f32_dpp v170, v170, v170 quad_perm:[2,3,0,1] row_mask:0xf bank_mask:0xf
    s_nop 1
    v_add_f32_dpp v170, v170, v170 row_half_mirror row_mask:0xf bank_mask:0xf
    s_nop 1
    v_add_f32_dpp v170, v170, v170 row_mirror row_mask:0xf bank_mask:0xf
    v_mov_b32 v171, v170
    s_nop 1
    v_permlane16_swap_b32 v171, v170
    v_add_f32 v170, v170, v171
    v_mul_f32 v170, 0x3acccccd, v170
    v_cvt_pk_bf16_f32 v169, v170, v168
    v_and_b32 v168, 0xffff0000, v169
    v_lshlrev_b32 v169, 16, v169
    v_add_f32 v169, 0x3727c5ac, v169
    v_cvt_pk_bf16_f32 v169, v169, v169
    v_lshlrev_b32 v169, 16, v169
    v_sqrt_f32 v169, v169
    s_nop 0
    v_cvt_pk_bf16_f32 v169, v169, v169
    v_lshlrev_b32 v169, 16, v169
    v_rcp_f32 v169, v169
    v_lshlrev_b32 v170, 3, v7
    v_add_u32 v170, s49, v170
    ds_write_b64 v170, v[168:169] offset:2320
    v_readfirstlane_b32 s50, v216
    v_readfirstlane_b32 s51, v217
    s_nop 0
    s_cmp_lg_u32 s50, 0
    s_cbranch_scc1 parallel_sum__softmax_full_mha__glu_gated_reglu__prompt_kernel_tagok
    v_mov_b32 v2, 0
    s_mov_b32 s33, 0
parallel_sum__softmax_full_mha__glu_gated_reglu__prompt_kernel_tg:
    buffer_load_dwordx2 v[216:217], v2, s[24:27], 0 offen sc1
    s_waitcnt vmcnt(0)
    v_readfirstlane_b32 s50, v216
    v_readfirstlane_b32 s51, v217
    s_add_u32 s33, s33, 1
    s_cmp_ge_u32 s33, 2097152
    s_cbranch_scc1 parallel_sum__softmax_full_mha__glu_gated_reglu__prompt_kernel_tg_x
    s_cmp_eq_u32 s50, 0
    s_cbranch_scc1 parallel_sum__softmax_full_mha__glu_gated_reglu__prompt_kernel_tg
parallel_sum__softmax_full_mha__glu_gated_reglu__prompt_kernel_tg_x:
parallel_sum__softmax_full_mha__glu_gated_reglu__prompt_kernel_tagok:
    v_mov_b32 v216, s50
    v_mov_b32 v217, s51
    v_mov_b32 v2, 0
    ds_write_b64 v2, v[216:217] offset:2304
    v_lshlrev_b32 v140, 16, v100
    v_and_b32 v141, 0xffff0000, v100
    v_lshlrev_b32 v142, 16, v101
    v_and_b32 v143, 0xffff0000, v101
    v_lshlrev_b32 v144, 16, v102
    v_and_b32 v145, 0xffff0000, v102
    v_lshlrev_b32 v146, 16, v103
    v_and_b32 v147, 0xffff0000, v103
    v_lshlrev_b32 v148, 16, v104
    v_and_b32 v149, 0xffff0000, v104
    v_add_f32 v140, v140, v148
    v_add_f32 v141, v141, v149
    v_lshlrev_b32 v150, 16, v105
    v_and_b32 v151, 0xffff0000, v105
    v_add_f32 v142, v142, v150
    v_add_f32 v143, v143, v151
    v_lshlrev_b32 v152, 16, v106
    v_and_b32 v153, 0xffff0000, v106
    v_add_f32 v144, v144, v152
    v_add_f32 v145, v145, v153
    v_lshlrev_b32 v154, 16, v107
    v_and_b32 v155, 0xffff0000, v107
    v_add_f32 v146, v146, v154
    v_add_f32 v147, v147, v155
    v_lshlrev_b32 v148, 16, v108
    v_and_b32 v149, 0xffff0000, v108
    v_add_f32 v140, v140, v148
    v_add_f32 v141, v141, v149
    v_lshlrev_b32 v150, 16, v109
    v_and_b32 v151, 0xffff0000, v109
    v_add_f32 v142, v142, v150
    v_add_f32 v143, v143, v151
    v_lshlrev_b32 v152, 16, v110
    v_and_b32 v153, 0xffff0000, v110
    v_add_f32 v144, v144, v152
    v_add_f32 v145, v145, v153
    v_lshlrev_b32 v154, 16, v111
    v_and_b32 v155, 0xffff0000, v111
    v_add_f32 v146, v146, v154
    v_add_f32 v147, v147, v155
    v_lshlrev_b32 v148, 16, v112
    v_and_b32 v149, 0xffff0000, v112
    v_add_f32 v140, v140, v148
    v_add_f32 v141, v141, v149
    v_lshlrev_b32 v150, 16, v113
    v_and_b32 v151, 0xffff0000, v113
    v_add_f32 v142, v142, v150
    v_add_f32 v143, v143, v151
    v_lshlrev_b32 v152, 16, v114
    v_and_b32 v153, 0xffff0000, v114
    v_add_f32 v144, v144, v152
    v_add_f32 v145, v145, v153
    v_lshlrev_b32 v154, 16, v115
    v_and_b32 v155, 0xffff0000, v115
    v_add_f32 v146, v146, v154
    v_add_f32 v147, v147, v155
    v_lshlrev_b32 v148, 16, v116
    v_and_b32 v149, 0xffff0000, v116
    v_add_f32 v140, v140, v148
    v_add_f32 v141, v141, v149
    v_lshlrev_b32 v150, 16, v117
    v_and_b32 v151, 0xffff0000, v117
    v_add_f32 v142, v142, v150
    v_add_f32 v143, v143, v151
    v_lshlrev_b32 v152, 16, v118
    v_and_b32 v153, 0xffff0000, v118
    v_add_f32 v144, v144, v152
    v_add_f32 v145, v145, v153
    v_lshlrev_b32 v154, 16, v119
    v_and_b32 v155, 0xffff0000, v119
    v_add_f32 v146, v146, v154
    v_add_f32 v147, v147, v155
    v_lshlrev_b32 v148, 16, v120
    v_and_b32 v149, 0xffff0000, v120
    v_add_f32 v140, v140, v148
    v_add_f32 v141, v141, v149
    v_lshlrev_b32 v150, 16, v121
    v_and_b32 v151, 0xffff0000, v121
    v_add_f32 v142, v142, v150
    v_add_f32 v143, v143, v151
    v_lshlrev_b32 v152, 16, v122
    v_and_b32 v153, 0xffff0000, v122
    v_add_f32 v144, v144, v152
    v_add_f32 v145, v145, v153
    v_lshlrev_b32 v154, 16, v123
    v_and_b32 v155, 0xffff0000, v123
    v_add_f32 v146, v146, v154
    v_add_f32 v147, v147, v155
    v_lshlrev_b32 v148, 16, v124
    v_and_b32 v149, 0xffff0000, v124
    v_add_f32 v140, v140, v148
    v_add_f32 v141, v141, v149
    v_lshlrev_b32 v150, 16, v125
    v_and_b32 v151, 0xffff0000, v125
    v_add_f32 v142, v142, v150
    v_add_f32 v143, v143, v151
    v_lshlrev_b32 v152, 16, v126
    v_and_b32 v153, 0xffff0000, v126
    v_add_f32 v144, v144, v152
    v_add_f32 v145, v145, v153
    v_lshlrev_b32 v154, 16, v127
    v_and_b32 v155, 0xffff0000, v127
    v_add_f32 v146, v146, v154
    v_add_f32 v147, v147, v155
    v_lshlrev_b32 v148, 16, v128
    v_and_b32 v149, 0xffff0000, v128
    v_add_f32 v140, v140, v148
    v_add_f32 v141, v141, v149
    v_lshlrev_b32 v150, 16, v129
    v_and_b32 v151, 0xffff0000, v129
    v_add_f32 v142, v142, v150
    v_add_f32 v143, v143, v151
    v_lshlrev_b32 v152, 16, v130
    v_and_b32 v153, 0xffff0000, v130
    v_add_f32 v144, v144, v152
    v_add_f32 v145, v145, v153
    v_lshlrev_b32 v154, 16, v131
    v_and_b32 v155, 0xffff0000, v131
    v_add_f32 v146, v146, v154
    v_add_f32 v147, v147, v155
    v_lshlrev_b32 v148, 16, v132
    v_and_b32 v149, 0xffff0000, v132
    v_add_f32 v140, v140, v148
    v_add_f32 v141, v141, v149
    v_lshlrev_b32 v150, 16, v133
    v_and_b32 v151, 0xffff0000, v133
    v_add_f32 v142, v142, v150
    v_add_f32 v143, v143, v151
    v_lshlrev_b32 v152, 16, v134
    v_and_b32 v153, 0xffff0000, v134
    v_add_f32 v144, v144, v152
    v_add_f32 v145, v145, v153
    v_lshlrev_b32 v154, 16, v135
    v_and_b32 v155, 0xffff0000, v135
    v_add_f32 v146, v146, v154
    v_add_f32 v147, v147, v155
    v_lshlrev_b32 v148, 16, v136
    v_and_b32 v149, 0xffff0000, v136
    v_add_f32 v140, v140, v148
    v_add_f32 v141, v141, v149
    v_lshlrev_b32 v150, 16, v137
    v_and_b32 v151, 0xffff0000, v137
    v_add_f32 v142, v142, v150
    v_add_f32 v143, v143, v151
    v_lshlrev_b32 v152, 16, v138
    v_and_b32 v153, 0xffff0000, v138
    v_add_f32 v144, v144, v152
    v_add_f32 v145, v145, v153
    v_lshlrev_b32 v154, 16, v139
    v_and_b32 v155, 0xffff0000, v139
    v_add_f32 v146, v146, v154
    v_add_f32 v147, v147, v155
    s_mov_b32 exec_hi, 0xff
    ds_write_b128 v172, v[140:143] offset:2560
    ds_write_b128 v172, v[144:147] offset:2576
    s_mov_b64 exec, -1
    s_waitcnt vmcnt(14) lgkmcnt(0)
    s_barrier
    s_add_u32 m0, s36, 8192
    s_nop 0
    buffer_load_dwordx4 v26, s[20:23], s37 offen lds
    buffer_load_dwordx4 v27, s[20:23], s37 offen offset:1024 lds
    s_add_u32 m0, s40, 8192
    s_add_u32 s37, s37, 122880
    buffer_load_dwordx4 v28, s[12:15], s35 offen lds
    buffer_load_dwordx4 v29, s[12:15], s35 offen offset:1024 lds
    buffer_load_dwordx4 v30, s[12:15], s35 offen offset:2048 lds
    s_add_u32 s35, s35, 98304
    s_cmp_lg_u32 s32, 0
    s_cbranch_scc1 parallel_sum__softmax_full_mha__glu_gated_reglu__prompt_kernel_o1
    ds_read_b128 v[176:179], v1 offset:2560
    ds_read_b128 v[180:183], v1 offset:3840
    ds_read_b128 v[184:187], v1 offset:5120
    ds_read_b128 v[188:191], v1 offset:6400
    ds_read_b128 v[192:195], v1 offset:3584
    ds_read_b128 v[196:199], v1 offset:4864
    ds_read_b128 v[200:203], v1 offset:6144
    ds_read_b128 v[204:207], v1 offset:7424
    ds_read_b128 v[208:211], v1 offset:2320
    s_lshl_b32 s33, s29, 4
    s_add_u32 s33, s33, s28
    s_mul_i32 s33, s33, 1280
    s_add_u32 s33, s33, 20168704
    s_lshl_b32 s34, s28, 10
    s_lshl_b32 s43, s29, 6
    s_add_u32 s34, s34, s43
    s_add_u32 s34, s34, 20496384
    s_waitcnt lgkmcnt(0)
    v_pk_add_f32 v[176:177], v[176:177], v[180:181]
    v_pk_add_f32 v[184:185], v[184:185], v[188:189]
    v_pk_add_f32 v[176:177], v[176:177], v[184:185]
    v_pk_add_f32 v[178:179], v[178:179], v[182:183]
    v_pk_add_f32 v[186:187], v[186:187], v[190:191]
    v_pk_add_f32 v[178:179], v[178:179], v[186:187]
    v_pk_add_f32 v[192:193], v[192:193], v[196:197]
    v_pk_add_f32 v[200:201], v[200:201], v[204:205]
    v_pk_add_f32 v[192:193], v[192:193], v[200:201]
    v_pk_add_f32 v[194:195], v[194:195], v[198:199]
    v_pk_add_f32 v[202:203], v[202:203], v[206:207]
    v_pk_add_f32 v[194:195], v[194:195], v[202:203]
    buffer_store_dwordx4 v[176:179], v1, s[60:63], s33 offen sc1
    s_mov_b64 exec, 0xffff
    buffer_store_dwordx4 v[192:195], v1, s[60:63], s33 offen offset:1024 sc1
    s_mov_b64 exec, 0xf
    buffer_store_dwordx4 v[208:211], v1, s[60:63], s34 offen sc1
    s_mov_b64 exec, -1
parallel_sum__softmax_full_mha__glu_gated_reglu__prompt_kernel_o1:
    s_cmp_lg_u32 s32, 1
    s_cbranch_scc1 parallel_sum__softmax_full_mha__glu_gated_reglu__prompt_kernel_ncl
    v_lshrrev_b32 v2, 3, v0
    v_mul_u32_u24 v2, 2560, v2
    v_add_u32 v2, v2, v1
    v_and_b32 v3, 7, v0
    v_cmp_eq_u32 vcc, 0, v3
    v_mov_b32 v3, 0x3f803f80
    s_nop 0
    v_cndmask_b32 v176, 0, v3, vcc
    v_cndmask_b32 v177, 0, v3, vcc
    v_cndmask_b32 v178, 0, v3, vcc
    v_cndmask_b32 v179, 0, v3, vcc
    s_mul_i32 s33, s2, 21504
    s_add_u32 s33, s33, 2624000
    buffer_store_dwordx4 v[176:179], v2, s[60:63], s33 offen sc1
parallel_sum__softmax_full_mha__glu_gated_reglu__prompt_kernel_ncl:
    s_load_dwordx2 s[68:69], s[0:1], 16
    s_load_dwordx2 s[72:73], s[0:1], 48
    s_lshl_b32 s64, s2, 2
    s_add_u32 s64, s64, s32
    s_mul_i32 s65, s64, 13108
    s_lshr_b32 s65, s65, 16
    s_mul_i32 s33, s65, 5
    s_sub_u32 s66, s64, s33
    v_lshrrev_b32 v2, 4, v0
    v_mul_u32_u24 v2, 1024, v2
    v_add_u32 v2, v2, v1
    s_mul_i32 s33, s65, 13108
    s_lshr_b32 s33, s33, 16
    s_mul_i32 s34, s33, 5
    s_sub_u32 s34, s65, s34
    s_mul_i32 s33, s33, 80
    s_mul_i32 s74, s34, 20
    s_add_u32 s74, s74, s33
    s_add_u32 s33, s33, 16
    s_cmp_eq_u32 s34, 4
    s_cselect_b32 s74, s33, s74
    s_cselect_b32 s43, 1, 0
    s_sub_u32 s33, s65, 40
    s_lshl_b32 s33, s33, 4
    s_mov_b32 s70, 819200
    s_mov_b32 s71, 0x20000
    s_waitcnt lgkmcnt(0)
    s_cmp_ge_u32 s65, 40
    s_cselect_b32 s68, s72, s68
    s_cselect_b32 s69, s73, s69
    s_cselect_b32 s70, 1966080, s70
    s_cselect_b32 s74, s33, s74
    s_cselect_b32 s43, 0, s43
    s_cmp_ge_u32 s64, 680
    s_cselect_b32 s70, 0, s70
    s_mul_i32 s74, s74, 1280
    s_lshl_b32 s34, s66, 8
    s_add_u32 s74, s74, s34
    s_lshl_b32 s67, s32, 12
    s_add_u32 s67, s67, 123008
    s_mov_b32 s33, 0
    s_cmp_eq_u32 s43, 1
    s_cselect_b32 s33, 0, s33
    s_add_u32 s33, s33, s74
    s_add_u32 m0, s67, 0
    s_nop 0
    buffer_load_dwordx4 v2, s[68:71], s33 offen lds
    s_mov_b32 s33, 5120
    s_cmp_eq_u32 s43, 1
    s_cselect_b32 s33, 51200, s33
    s_add_u32 s33, s33, s74
    s_add_u32 m0, s67, 1024
    s_nop 0
    buffer_load_dwordx4 v2, s[68:71], s33 offen lds
    s_mov_b32 s33, 10240
    s_cmp_eq_u32 s43, 1
    s_cselect_b32 s33, 25600, s33
    s_add_u32 s33, s33, s74
    s_add_u32 m0, s67, 2048
    s_nop 0
    buffer_load_dwordx4 v2, s[68:71], s33 offen lds
    s_mov_b32 s33, 15360
    s_cmp_eq_u32 s43, 1
    s_cselect_b32 s33, 76800, s33
    s_add_u32 s33, s33, s74
    s_add_u32 m0, s67, 3072
    s_nop 0
    buffer_load_dwordx4 v2, s[68:71], s33 offen lds
    s_waitcnt vmcnt(14) lgkmcnt(0)
    s_barrier
    s_cmp_ge_u32 s42, 10
    s_cselect_b32 s10, 0, s10
    s_add_u32 m0, s47, 0
    s_add_u32 s42, s42, 1
    buffer_load_dwordx4 v31, s[8:11], s38 offen lds
    buffer_load_dwordx4 v32, s[8:11], s38 offen offset:1024 lds
    buffer_load_dwordx4 v33, s[8:11], s38 offen offset:2048 lds
    buffer_load_dwordx4 v34, s[8:11], s38 offen offset:3072 lds
    s_add_u32 s38, s38, 128
    s_add_u32 m0, s36, 28704
    s_nop 0
    buffer_load_dwordx4 v26, s[20:23], s37 offen lds
    buffer_load_dwordx4 v27, s[20:23], s37 offen offset:1024 lds
    s_add_u32 m0, s40, 28704
    s_add_u32 s37, s37, 122880
    buffer_load_dwordx4 v28, s[12:15], s35 offen lds
    buffer_load_dwordx4 v29, s[12:15], s35 offen offset:1024 lds
    buffer_load_dwordx4 v30, s[12:15], s35 offen offset:2048 lds
    s_add_u32 s35, s35, 98304
    s_waitcnt vmcnt(18) lgkmcnt(0)
    s_barrier
    s_add_u32 m0, s36, 49216
    s_nop 0
    buffer_load_dwordx4 v26, s[20:23], s37 offen lds
    buffer_load_dwordx4 v27, s[20:23], s37 offen offset:1024 lds
    s_add_u32 m0, s40, 49216
    s_add_u32 s37, s37, 122880
    buffer_load_dwordx4 v28, s[12:15], s35 offen lds
    buffer_load_dwordx4 v29, s[12:15], s35 offen offset:1024 lds
    buffer_load_dwordx4 v30, s[12:15], s35 offen offset:2048 lds
    s_add_u32 s35, s35, 98304
    s_waitcnt vmcnt(10) lgkmcnt(0)
    s_barrier
    s_cmp_ge_u32 s42, 10
    s_cselect_b32 s10, 0, s10
    s_add_u32 m0, s47, 16384
    s_add_u32 s42, s42, 1
    buffer_load_dwordx4 v31, s[8:11], s38 offen lds
    buffer_load_dwordx4 v32, s[8:11], s38 offen offset:1024 lds
    buffer_load_dwordx4 v33, s[8:11], s38 offen offset:2048 lds
    buffer_load_dwordx4 v34, s[8:11], s38 offen offset:3072 lds
    s_add_u32 s38, s38, 128
    s_add_u32 m0, s36, 69728
    s_nop 0
    buffer_load_dwordx4 v26, s[20:23], s37 offen lds
    buffer_load_dwordx4 v27, s[20:23], s37 offen offset:1024 lds
    s_add_u32 m0, s40, 69728
    s_add_u32 s37, s37, 122880
    buffer_load_dwordx4 v28, s[12:15], s35 offen lds
    buffer_load_dwordx4 v29, s[12:15], s35 offen offset:1024 lds
    buffer_load_dwordx4 v30, s[12:15], s35 offen offset:2048 lds
    s_add_u32 s35, s35, 98304
    s_cmp_lg_u32 s32, 0
    s_cbranch_scc1 parallel_sum__softmax_full_mha__glu_gated_reglu__prompt_kernel_o2
    s_waitcnt vmcnt(9)
    s_lshl_b32 s49, s28, 4
    s_add_u32 s49, s49, s29
    s_lshl_b32 s33, s49, 7
    s_add_u32 s33, s33, 19906560
    v_mov_b32 v216, s50
    v_mov_b32 v217, s51
    v_mov_b32 v2, 0
    s_mov_b64 exec, 1
    buffer_store_dwordx2 v[216:217], v2, s[60:63], s33 offen sc1
    s_mov_b64 exec, -1
parallel_sum__softmax_full_mha__glu_gated_reglu__prompt_kernel_o2:
    s_waitcnt vmcnt(14) lgkmcnt(0)
    s_barrier
    s_add_u32 m0, s36, 8192
    s_nop 0
    buffer_load_dwordx4 v26, s[20:23], s37 offen lds
    buffer_load_dwordx4 v27, s[20:23], s37 offen offset:1024 lds
    s_add_u32 m0, s40, 8192
    s_add_u32 s37, s37, 122880
    buffer_load_dwordx4 v28, s[12:15], s35 offen lds
    buffer_load_dwordx4 v29, s[12:15], s35 offen offset:1024 lds
    buffer_load_dwordx4 v30, s[12:15], s35 offen offset:2048 lds
    s_add_u32 s35, s35, 98304
    s_waitcnt vmcnt(10) lgkmcnt(0)
    s_barrier
    s_cmp_ge_u32 s42, 10
    s_cselect_b32 s10, 0, s10
    s_add_u32 m0, s47, 0
    s_add_u32 s42, s42, 1
    buffer_load_dwordx4 v31, s[8:11], s38 offen lds
    buffer_load_dwordx4 v32, s[8:11], s38 offen offset:1024 lds
    buffer_load_dwordx4 v33, s[8:11], s38 offen offset:2048 lds
    buffer_load_dwordx4 v34, s[8:11], s38 offen offset:3072 lds
    s_add_u32 s38, s38, 128
    s_add_u32 m0, s36, 28704
    s_nop 0
    buffer_load_dwordx4 v26, s[20:23], s37 offen lds
    buffer_load_dwordx4 v27, s[20:23], s37 offen offset:1024 lds
    s_add_u32 m0, s40, 28704
    s_add_u32 s37, s37, 122880
    buffer_load_dwordx4 v28, s[12:15], s35 offen lds
    buffer_load_dwordx4 v29, s[12:15], s35 offen offset:1024 lds
    buffer_load_dwordx4 v30, s[12:15], s35 offen offset:2048 lds
    s_add_u32 s35, s35, 98304
    s_waitcnt vmcnt(14) lgkmcnt(0)
    s_barrier
    s_add_u32 m0, s36, 49216
    s_nop 0
    buffer_load_dwordx4 v26, s[20:23], s37 offen lds
    buffer_load_dwordx4 v27, s[20:23], s37 offen offset:1024 lds
    s_add_u32 m0, s40, 49216
    s_add_u32 s37, s37, 122880
    buffer_load_dwordx4 v28, s[12:15], s35 offen lds
    buffer_load_dwordx4 v29, s[12:15], s35 offen offset:1024 lds
    buffer_load_dwordx4 v30, s[12:15], s35 offen offset:2048 lds
    s_add_u32 s35, s35, 98304
    s_waitcnt vmcnt(10) lgkmcnt(0)
    s_barrier
    s_cmp_ge_u32 s42, 10
    s_cselect_b32 s10, 0, s10
    s_add_u32 m0, s47, 16384
    s_add_u32 s42, s42, 1
    buffer_load_dwordx4 v31, s[8:11], s38 offen lds
    buffer_load_dwordx4 v32, s[8:11], s38 offen offset:1024 lds
    buffer_load_dwordx4 v33, s[8:11], s38 offen offset:2048 lds
    buffer_load_dwordx4 v34, s[8:11], s38 offen offset:3072 lds
    s_add_u32 s38, s38, 128
    s_add_u32 m0, s36, 69728
    s_nop 0
    buffer_load_dwordx4 v26, s[20:23], s37 offen lds
    buffer_load_dwordx4 v27, s[20:23], s37 offen offset:1024 lds
    s_add_u32 m0, s40, 69728
    s_add_u32 s37, s37, 122880
    buffer_load_dwordx4 v28, s[12:15], s35 offen lds
    buffer_load_dwordx4 v29, s[12:15], s35 offen offset:1024 lds
    buffer_load_dwordx4 v30, s[12:15], s35 offen offset:2048 lds
    s_add_u32 s35, s35, 98304
    s_waitcnt vmcnt(14) lgkmcnt(0)
    s_barrier
    s_add_u32 m0, s36, 8192
    s_nop 0
    buffer_load_dwordx4 v26, s[20:23], s37 offen lds
    buffer_load_dwordx4 v27, s[20:23], s37 offen offset:1024 lds
    s_add_u32 m0, s40, 8192
    s_add_u32 s37, s37, 122880
    buffer_load_dwordx4 v28, s[12:15], s35 offen lds
    buffer_load_dwordx4 v29, s[12:15], s35 offen offset:1024 lds
    buffer_load_dwordx4 v30, s[12:15], s35 offen offset:2048 lds
    s_add_u32 s35, s35, 98304
    s_waitcnt vmcnt(10) lgkmcnt(0)
    s_barrier
    s_cmp_ge_u32 s42, 10
    s_cselect_b32 s10, 0, s10
    s_add_u32 m0, s47, 0
    s_add_u32 s42, s42, 1
    buffer_load_dwordx4 v31, s[8:11], s38 offen lds
    buffer_load_dwordx4 v32, s[8:11], s38 offen offset:1024 lds
    buffer_load_dwordx4 v33, s[8:11], s38 offen offset:2048 lds
    buffer_load_dwordx4 v34, s[8:11], s38 offen offset:3072 lds
    s_add_u32 s38, s38, 128
    s_add_u32 m0, s36, 28704
    s_nop 0
    buffer_load_dwordx4 v26, s[20:23], s37 offen lds
    buffer_load_dwordx4 v27, s[20:23], s37 offen offset:1024 lds
    s_add_u32 m0, s40, 28704
    s_add_u32 s37, s37, 122880
    buffer_load_dwordx4 v28, s[12:15], s35 offen lds
    buffer_load_dwordx4 v29, s[12:15], s35 offen offset:1024 lds
    buffer_load_dwordx4 v30, s[12:15], s35 offen offset:2048 lds
    s_add_u32 s35, s35, 98304
    s_waitcnt vmcnt(14) lgkmcnt(0)
    s_barrier
    s_add_u32 m0, s36, 49216
    s_nop 0
    buffer_load_dwordx4 v26, s[20:23], s37 offen lds
    buffer_load_dwordx4 v27, s[20:23], s37 offen offset:1024 lds
    s_add_u32 m0, s40, 49216
    s_add_u32 s37, s37, 122880
    buffer_load_dwordx4 v28, s[12:15], s35 offen lds
    buffer_load_dwordx4 v29, s[12:15], s35 offen offset:1024 lds
    buffer_load_dwordx4 v30, s[12:15], s35 offen offset:2048 lds
    s_add_u32 s35, s35, 98304
    s_waitcnt vmcnt(10) lgkmcnt(0)
    s_barrier
    s_cmp_ge_u32 s42, 10
    s_cselect_b32 s10, 0, s10
    s_add_u32 m0, s47, 16384
    s_add_u32 s42, s42, 1
    buffer_load_dwordx4 v31, s[8:11], s38 offen lds
    buffer_load_dwordx4 v32, s[8:11], s38 offen offset:1024 lds
    buffer_load_dwordx4 v33, s[8:11], s38 offen offset:2048 lds
    buffer_load_dwordx4 v34, s[8:11], s38 offen offset:3072 lds
    s_add_u32 s38, s38, 128
    s_add_u32 m0, s36, 69728
    s_nop 0
    buffer_load_dwordx4 v26, s[20:23], s37 offen lds
    buffer_load_dwordx4 v27, s[20:23], s37 offen offset:1024 lds
    s_add_u32 m0, s40, 69728
    s_add_u32 s37, s37, 122880
    buffer_load_dwordx4 v28, s[12:15], s35 offen lds
    buffer_load_dwordx4 v29, s[12:15], s35 offen offset:1024 lds
    buffer_load_dwordx4 v30, s[12:15], s35 offen offset:2048 lds
    s_add_u32 s35, s35, 98304
    v_bfe_u32 v2, v0, 2, 2
    v_lshl_add_u32 v2, v7, 2, v2
    v_lshlrev_b32 v2, 8, v2
    v_bfe_u32 v3, v0, 4, 1
    v_lshl_add_u32 v2, v3, 5, v2
    v_and_b32 v3, 3, v0
    v_lshl_add_u32 v2, v3, 3, v2
    v_add_u32 v2, s67, v2
    ds_read_b64_tr_b16 v[100:101], v2 offset:0
    ds_read_b64_tr_b16 v[102:103], v2 offset:2048
    ds_read_b64_tr_b16 v[104:105], v2 offset:64
    ds_read_b64_tr_b16 v[106:107], v2 offset:2112
    ds_read_b64_tr_b16 v[108:109], v2 offset:128
    ds_read_b64_tr_b16 v[110:111], v2 offset:2176
    ds_read_b64_tr_b16 v[112:113], v2 offset:192
    ds_read_b64_tr_b16 v[114:115], v2 offset:2240
    s_mul_i32 s33, s66, 557056
    s_lshl_b32 s34, s65, 10
    s_add_u32 s33, s33, s34
    s_add_u32 s33, s33, 17121280
    s_cmp_ge_u32 s64, 680
    s_cselect_b32 s62, 0, s62
    s_waitcnt lgkmcnt(6)
    buffer_store_dwordx4 v[100:103], v1, s[60:63], s33 offen sc1
    s_add_u32 s33, s33, 139264
    s_waitcnt lgkmcnt(4)
    buffer_store_dwordx4 v[104:107], v1, s[60:63], s33 offen sc1
    s_add_u32 s33, s33, 139264
    s_waitcnt lgkmcnt(2)
    buffer_store_dwordx4 v[108:111], v1, s[60:63], s33 offen sc1
    s_add_u32 s33, s33, 139264
    s_waitcnt lgkmcnt(0)
    buffer_store_dwordx4 v[112:115], v1, s[60:63], s33 offen sc1
    s_add_u32 s33, s33, 139264
    s_mov_b32 s62, 20512768
    v_and_b32 v2, 15, v0
    v_lshlrev_b32 v3, 4, v2
    v_add_u32 v3, s29, v3
    s_lshl_b32 s33, s28, 4
    v_add_u32 v2, s33, v2
    v_and_b32 v4, 16, v0
    v_cmp_eq_u32 vcc, 0, v4
    s_nop 1
    v_cndmask_b32 v218, v2, v3, vcc
    v_lshlrev_b32 v218, 7, v218
    s_mov_b32 s33, 19906560
    buffer_load_dwordx2 v[176:177], v218, s[60:63], s33 offen sc1
    s_waitcnt vmcnt(19) lgkmcnt(0)
    s_barrier
    s_waitcnt vmcnt(10) lgkmcnt(0)
    s_barrier
    s_waitcnt vmcnt(0)
    v_xor_b32 v176, s50, v176
    v_xor_b32 v177, s51, v177
    v_or_b32 v176, v176, v177
    v_cmp_ne_u32 vcc, 0, v176
    s_nop 4
    s_cbranch_vccz parallel_sum__softmax_full_mha__glu_gated_reglu__prompt_kernel_stok
    s_mov_b32 s34, 0
    s_mov_b32 s33, 19906560
parallel_sum__softmax_full_mha__glu_gated_reglu__prompt_kernel_stw:
    buffer_load_dwordx2 v[176:177], v218, s[60:63], s33 offen sc1
    s_waitcnt vmcnt(0)
    v_xor_b32 v176, s50, v176
    v_xor_b32 v177, s51, v177
    v_or_b32 v176, v176, v177
    v_cmp_ne_u32 vcc, 0, v176
    s_add_u32 s34, s34, 1
    s_cmp_ge_u32 s34, 2097152
    s_cbranch_scc1 parallel_sum__softmax_full_mha__glu_gated_reglu__prompt_kernel_stw_x
    s_nop 1
    s_cbranch_vccnz parallel_sum__softmax_full_mha__glu_gated_reglu__prompt_kernel_stw
parallel_sum__softmax_full_mha__glu_gated_reglu__prompt_kernel_stw_x:
parallel_sum__softmax_full_mha__glu_gated_reglu__prompt_kernel_stok:
    v_lshrrev_b32 v2, 4, v0
    v_mul_u32_u24 v2, 1024, v2
    v_add_u32 v2, v2, v1
    s_mul_i32 s33, s29, 20480
    s_add_u32 s33, s33, 20168704
    s_lshl_b32 s34, s32, 8
    s_add_u32 s34, s34, s33
    buffer_load_dwordx4 v[176:179], v2, s[60:63], s34 offen sc1
    buffer_load_dwordx4 v[192:195], v2, s[60:63], s33 offen offset:1024 sc1
    s_add_u32 s33, s33, 5120
    s_add_u32 s34, s34, 5120
    buffer_load_dwordx4 v[180:183], v2, s[60:63], s34 offen sc1
    buffer_load_dwordx4 v[196:199], v2, s[60:63], s33 offen offset:1024 sc1
    s_add_u32 s33, s33, 5120
    s_add_u32 s34, s34, 5120
    buffer_load_dwordx4 v[184:187], v2, s[60:63], s34 offen sc1
    buffer_load_dwordx4 v[200:203], v2, s[60:63], s33 offen offset:1024 sc1
    s_add_u32 s33, s33, 5120
    s_add_u32 s34, s34, 5120
    buffer_load_dwordx4 v[188:191], v2, s[60:63], s34 offen sc1
    buffer_load_dwordx4 v[204:207], v2, s[60:63], s33 offen offset:1024 sc1
    s_lshl_b32 s33, s28, 10
    s_add_u32 s33, s33, 20496384
    buffer_load_dwordx4 v[208:211], v1, s[60:63], s33 offen sc1
    s_waitcnt lgkmcnt(0)
    s_barrier
    s_waitcnt lgkmcnt(0)
    s_barrier
    s_waitcnt vmcnt(0)
    v_pk_add_f32 v[176:177], v[176:177], v[180:181]
    v_pk_add_f32 v[184:185], v[184:185], v[188:189]
    v_pk_add_f32 v[176:177], v[176:177], v[184:185]
    v_pk_add_f32 v[178:179], v[178:179], v[182:183]
    v_pk_add_f32 v[186:187], v[186:187], v[190:191]
    v_pk_add_f32 v[178:179], v[178:179], v[186:187]
    v_pk_add_f32 v[192:193], v[192:193], v[196:197]
    v_pk_add_f32 v[200:201], v[200:201], v[204:205]
    v_pk_add_f32 v[192:193], v[192:193], v[200:201]
    v_pk_add_f32 v[194:195], v[194:195], v[198:199]
    v_pk_add_f32 v[202:203], v[202:203], v[206:207]
    v_pk_add_f32 v[194:195], v[194:195], v[202:203]
    v_mov_b32 v180, v176
    v_mov_b32 v181, v177
    v_mov_b32 v182, v178
    v_mov_b32 v183, v179
    v_mov_b32 v196, v192
    v_mov_b32 v197, v193
    v_mov_b32 v198, v194
    v_mov_b32 v199, v195
    v_permlane16_swap_b32 v180, v176
    v_permlane16_swap_b32 v181, v177
    v_permlane16_swap_b32 v182, v178
    v_permlane16_swap_b32 v183, v179
    v_permlane16_swap_b32 v196, v192
    v_permlane16_swap_b32 v197, v193
    v_permlane16_swap_b32 v198, v194
    v_permlane16_swap_b32 v199, v195
    v_add_f32 v176, v176, v180
    v_add_f32 v177, v177, v181
    v_add_f32 v178, v178, v182
    v_add_f32 v179, v179, v183
    v_add_f32 v192, v192, v196
    v_add_f32 v193, v193, v197
    v_add_f32 v194, v194, v198
    v_add_f32 v195, v195, v199
    v_mov_b32 v180, v176
    v_mov_b32 v181, v177
    v_mov_b32 v182, v178
    v_mov_b32 v183, v179
    v_mov_b32 v196, v192
    v_mov_b32 v197, v193
    v_mov_b32 v198, v194
    v_mov_b32 v199, v195
    v_permlane32_swap_b32 v180, v176
    v_permlane32_swap_b32 v181, v177
    v_permlane32_swap_b32 v182, v178
    v_permlane32_swap_b32 v183, v179
    v_permlane32_swap_b32 v196, v192
    v_permlane32_swap_b32 v197, v193
    v_permlane32_swap_b32 v198, v194
    v_permlane32_swap_b32 v199, v195
    v_add_f32 v176, v176, v180
    v_add_f32 v177, v177, v181
    v_add_f32 v178, v178, v182
    v_add_f32 v179, v179, v183
    v_add_f32 v192, v192, v196
    v_add_f32 v193, v193, v197
    v_add_f32 v194, v194, v198
    v_add_f32 v195, v195, v199
    v_and_b32 v2, 15, v0
    v_lshlrev_b32 v2, 4, v2
    s_lshl_b32 s33, s32, 8
    v_add_u32 v3, s33, v2
    ds_write_b128 v3, v[176:179] offset:1024
    ds_write_b128 v2, v[192:195] offset:2048
    v_lshlrev_b32 v2, 3, v0
    v_mov_b32 v212, v209
    v_mov_b32 v209, v210
    v_mov_b32 v213, v211
    ds_write_b64 v2, v[208:209] offset:0
    ds_write_b64 v2, v[212:213] offset:512
    s_waitcnt vmcnt(0) lgkmcnt(0)
    s_barrier
    v_lshlrev_b32 v218, 7, v0
    s_barrier
    s_cmp_lg_u32 s32, 0
    s_cbranch_scc1 parallel_sum__softmax_full_mha__glu_gated_reglu__prompt_kernel_nq
    s_lshl_b32 s49, s28, 4
    s_add_u32 s49, s49, s29
    s_lshl_b32 s33, s49, 7
    s_add_u32 s33, s33, 19939328
    v_mov_b32 v216, s50
    v_mov_b32 v217, s51
    v_mov_b32 v2, 0
    s_mov_b64 exec, 1
    buffer_store_dwordx2 v[216:217], v2, s[60:63], s33 offen sc1
    s_mov_b64 exec, -1
    s_mov_b32 s34, 0
    s_mov_b32 s33, 19939328
    s_branch parallel_sum__softmax_full_mha__glu_gated_reglu__prompt_kernel_qw_f
parallel_sum__softmax_full_mha__glu_gated_reglu__prompt_kernel_qw:
    s_sleep 4
parallel_sum__softmax_full_mha__glu_gated_reglu__prompt_kernel_qw_f:
    buffer_load_dwordx2 v[176:177], v218, s[60:63], s33 offen sc1
    s_add_u32 s33, s33, 8192
    buffer_load_dwordx2 v[178:179], v218, s[60:63], s33 offen sc1
    s_add_u32 s33, s33, 8192
    buffer_load_dwordx2 v[180:181], v218, s[60:63], s33 offen sc1
    s_add_u32 s33, s33, 8192
    buffer_load_dwordx2 v[182:183], v218, s[60:63], s33 offen sc1
    s_sub_u32 s33, s33, 24576
    s_waitcnt vmcnt(0)
    v_xor_b32 v176, s50, v176
    v_xor_b32 v177, s51, v177
    v_xor_b32 v178, s50, v178
    v_xor_b32 v179, s51, v179
    v_xor_b32 v180, s50, v180
    v_xor_b32 v181, s51, v181
    v_xor_b32 v182, s50, v182
    v_xor_b32 v183, s51, v183
    v_or_b32 v176, v176, v177
    v_or_b32 v176, v176, v178
    v_or_b32 v176, v176, v179
    v_or_b32 v176, v176, v180
    v_or_b32 v176, v176, v181
    v_or_b32 v176, v176, v182
    v_or_b32 v176, v176, v183
    v_cmp_ne_u32 vcc, 0, v176
    s_add_u32 s34, s34, 1
    s_cmp_ge_u32 s34, 2097152
    s_cbranch_scc1 parallel_sum__softmax_full_mha__glu_gated_reglu__prompt_kernel_qw_x
    s_nop 1
    s_cbranch_vccnz parallel_sum__softmax_full_mha__glu_gated_reglu__prompt_kernel_qw
parallel_sum__softmax_full_mha__glu_gated_reglu__prompt_kernel_qw_x:
parallel_sum__softmax_full_mha__glu_gated_reglu__prompt_kernel_nq:
    s_barrier
    s_setprio 0
    s_lshl_b32 s33, s28, 2
    s_lshl_b32 s34, s31, 1
    s_add_u32 s33, s33, s34
    s_mul_i32 s33, s33, 139264
    s_mul_i32 s34, s29, 6144
    s_add_u32 s33, s33, s34
    s_mul_i32 s34, s30, 3072
    s_add_u32 s33, s33, s34
    s_add_u32 s33, s33, 8249344
    s_add_u32 s43, s33, 139264
    s_mul_i32 s34, s32, 6144
    v_add_u32 v2, s34, v1
    ds_read_b128 v[100:103], v2 offset:8192
    ds_read_b128 v[104:107], v2 offset:9216
    ds_read_b128 v[108:111], v2 offset:10240
    ds_read_b128 v[112:115], v2 offset:11264
    ds_read_b128 v[116:119], v2 offset:12288
    ds_read_b128 v[120:123], v2 offset:13312
    s_waitcnt lgkmcnt(5)
    buffer_store_dwordx4 v[100:103], v1, s[60:63], s33 offen offset:0 sc1
    s_waitcnt vmcnt(0)
    s_waitcnt lgkmcnt(4)
    buffer_store_dwordx4 v[104:107], v1, s[60:63], s33 offen offset:1024 sc1
    s_waitcnt vmcnt(0)
    s_waitcnt lgkmcnt(3)
    buffer_store_dwordx4 v[108:111], v1, s[60:63], s33 offen offset:2048 sc1
    s_waitcnt vmcnt(0)
    s_waitcnt lgkmcnt(2)
    buffer_store_dwordx4 v[112:115], v1, s[60:63], s43 offen offset:0 sc1
    s_waitcnt vmcnt(0)
    s_waitcnt lgkmcnt(1)
    buffer_store_dwordx4 v[116:119], v1, s[60:63], s43 offen offset:1024 sc1
    s_waitcnt vmcnt(0)
    s_waitcnt lgkmcnt(0)
    buffer_store_dwordx4 v[120:123], v1, s[60:63], s43 offen offset:2048 sc1
    s_waitcnt vmcnt(0)
    s_waitcnt vmcnt(0)
    v_mov_b32 v176, 1
    s_mov_b64 exec, 1
    ds_add_u32 v219, v176 offset:0
    s_mov_b64 exec, -1
    s_cmp_lg_u32 s32, 0
    s_cbranch_scc1 parallel_sum__softmax_full_mha__glu_gated_reglu__prompt_kernel_nh
    s_branch parallel_sum__softmax_full_mha__glu_gated_reglu__prompt_kernel_hc_f
parallel_sum__softmax_full_mha__glu_gated_reglu__prompt_kernel_hc:
    s_sleep 16
parallel_sum__softmax_full_mha__glu_gated_reglu__prompt_kernel_hc_f:
    ds_read_b32 v176, v219 offset:0
    s_waitcnt lgkmcnt(0)
    v_readfirstlane_b32 s33, v176
    s_nop 1
    s_cmp_lt_u32 s33, 4
    s_cbranch_scc1 parallel_sum__softmax_full_mha__glu_gated_reglu__prompt_kernel_hc
    s_lshl_b32 s49, s28, 4
    s_add_u32 s49, s49, s29
    s_lshl_b32 s33, s49, 7
    s_add_u32 s33, s33, 19972096
    v_mov_b32 v216, s50
    v_mov_b32 v217, s51
    v_mov_b32 v2, 0
    s_mov_b64 exec, 1
    buffer_store_dwordx2 v[216:217], v2, s[60:63], s33 offen sc1
    s_mov_b64 exec, -1
    s_mov_b32 s34, 0
    s_mov_b32 s33, 19972096
    s_branch parallel_sum__softmax_full_mha__glu_gated_reglu__prompt_kernel_hw_f
parallel_sum__softmax_full_mha__glu_gated_reglu__prompt_kernel_hw:
    s_sleep 64
parallel_sum__softmax_full_mha__glu_gated_reglu__prompt_kernel_hw_f:
    buffer_load_dwordx2 v[176:177], v218, s[60:63], s33 offen sc1
    s_add_u32 s33, s33, 8192
    buffer_load_dwordx2 v[178:179], v218, s[60:63], s33 offen sc1
    s_add_u32 s33, s33, 8192
    buffer_load_dwordx2 v[180:181], v218, s[60:63], s33 offen sc1
    s_add_u32 s33, s33, 8192
    buffer_load_dwordx2 v[182:183], v218, s[60:63], s33 offen sc1
    s_sub_u32 s33, s33, 24576
    s_waitcnt vmcnt(0)
    v_xor_b32 v176, s50, v176
    v_xor_b32 v177, s51, v177
    v_xor_b32 v178, s50, v178
    v_xor_b32 v179, s51, v179
    v_xor_b32 v180, s50, v180
    v_xor_b32 v181, s51, v181
    v_xor_b32 v182, s50, v182
    v_xor_b32 v183, s51, v183
    v_or_b32 v176, v176, v177
    v_or_b32 v176, v176, v178
    v_or_b32 v176, v176, v179
    v_or_b32 v176, v176, v180
    v_or_b32 v176, v176, v181
    v_or_b32 v176, v176, v182
    v_or_b32 v176, v176, v183
    v_cmp_ne_u32 vcc, 0, v176
    s_add_u32 s34, s34, 1
    s_cmp_ge_u32 s34, 2097152
    s_cbranch_scc1 parallel_sum__softmax_full_mha__glu_gated_reglu__prompt_kernel_hw_x
    s_nop 1
    s_cbranch_vccnz parallel_sum__softmax_full_mha__glu_gated_reglu__prompt_kernel_hw
parallel_sum__softmax_full_mha__glu_gated_reglu__prompt_kernel_hw_x:
    v_mov_b32 v176, 1
    ds_write_b32 v219, v176 offset:4
parallel_sum__softmax_full_mha__glu_gated_reglu__prompt_kernel_nh:
    s_branch parallel_sum__softmax_full_mha__glu_gated_reglu__prompt_kernel_go_f
parallel_sum__softmax_full_mha__glu_gated_reglu__prompt_kernel_go:
    s_sleep 64
parallel_sum__softmax_full_mha__glu_gated_reglu__prompt_kernel_go_f:
    ds_read_b32 v176, v219 offset:4
    s_waitcnt lgkmcnt(0)
    v_readfirstlane_b32 s33, v176
    s_nop 1
    s_cmp_lt_u32 s33, 1
    s_cbranch_scc1 parallel_sum__softmax_full_mha__glu_gated_reglu__prompt_kernel_go
    s_and_b32 s6, s2, 7
    s_lshr_b32 s7, s2, 3
    s_lshr_b32 s33, s7, 3
    s_and_b32 s4, s6, 1
    s_lshl_b32 s4, s4, 2
    s_add_u32 s33, s33, s4
    s_cmp_ge_u32 s33, 7
    s_cbranch_scc1 parallel_sum__softmax_full_mha__glu_gated_reglu__prompt_kernel_nopre
    s_lshr_b32 s6, s6, 1
    s_lshl_b32 s6, s6, 3
    s_and_b32 s7, s7, 7
    s_add_u32 s6, s6, s7
    s_mul_i32 s6, s6, 278528
    s_add_u32 s6, s6, 8249344
    s_mul_i32 s7, s33, 417792
    s_add_u32 s7, s7, 17162240
    s_mov_b32 s62, 19906560
    s_lshl_b32 s4, s32, 10
    v_add_u32 v3, s4, v1
    s_mov_b32 s5, 0
parallel_sum__softmax_full_mha__glu_gated_reglu__prompt_kernel_pst:
    s_cmp_lt_u32 s5, 2
    s_cselect_b32 s34, s6, s7
    s_add_u32 m0, s4, 0
    s_add_u32 s33, s34, 0
    buffer_load_dwordx4 v3, s[60:63], s33 offen sc1 lds
    s_waitcnt vmcnt(2)
    s_add_u32 m0, s4, 4096
    s_add_u32 s33, s34, 4096
    buffer_load_dwordx4 v3, s[60:63], s33 offen sc1 lds
    s_waitcnt vmcnt(2)
    s_add_u32 m0, s4, 8192
    s_add_u32 s33, s34, 8192
    buffer_load_dwordx4 v3, s[60:63], s33 offen sc1 lds
    s_waitcnt vmcnt(2)
    s_add_u32 m0, s4, 12288
    s_add_u32 s33, s34, 12288
    buffer_load_dwordx4 v3, s[60:63], s33 offen sc1 lds
    s_waitcnt vmcnt(2)
    s_add_u32 m0, s4, 16384
    s_add_u32 s33, s34, 16384
    buffer_load_dwordx4 v3, s[60:63], s33 offen sc1 lds
    s_waitcnt vmcnt(2)
    s_add_u32 m0, s4, 20480
    s_add_u32 s33, s34, 20480
    buffer_load_dwordx4 v3, s[60:63], s33 offen sc1 lds
    s_waitcnt vmcnt(2)
    s_cmp_lt_u32 s5, 2
    s_cselect_b32 s33, 139264, 0
    s_add_u32 s6, s6, s33
    s_cmp_lt_u32 s5, 2
    s_cselect_b32 s33, 0, 139264
    s_add_u32 s7, s7, s33
    s_add_u32 s4, s4, 24576
    s_add_u32 s5, s5, 1
    s_cmp_lt_u32 s5, 5
    s_cbranch_scc1 parallel_sum__softmax_full_mha__glu_gated_reglu__prompt_kernel_pst
    s_waitcnt vmcnt(0)
parallel_sum__softmax_full_mha__glu_gated_reglu__prompt_kernel_nopre:
    v_mov_b32 v176, 1
    s_mov_b64 exec, 1
    ds_add_u32 v219, v176 offset:8
    s_mov_b64 exec, -1
    s_waitcnt lgkmcnt(0)
    s_branch parallel_sum__softmax_full_mha__glu_gated_reglu__prompt_kernel_end
parallel_sum__softmax_full_mha__glu_gated_reglu__prompt_kernel_comp:
    s_setprio 1
    s_mov_b32 s62, 20512768
    s_mov_b32 s63, 0x20000
    s_mov_b32 s44, -1
    s_mov_b32 s45, 0
    s_waitcnt lgkmcnt(0)
    v_mov_b32 v82, 0
    v_mov_b32 v83, 0
    v_mov_b32 v84, 0
    v_mov_b32 v85, 0
    v_mov_b32 v86, 0
    v_mov_b32 v87, 0
    v_mov_b32 v88, 0
    v_mov_b32 v89, 0
    v_mov_b32 v90, 0
    v_mov_b32 v91, 0
    v_mov_b32 v92, 0
    v_mov_b32 v93, 0
    v_mov_b32 v94, 0
    v_mov_b32 v95, 0
    v_mov_b32 v96, 0
    v_mov_b32 v97, 0
    v_mov_b32 v98, 0
    v_mov_b32 v99, 0
    v_mov_b32 v100, 0
    v_mov_b32 v101, 0
    v_mov_b32 v102, 0
    v_mov_b32 v103, 0
    v_mov_b32 v104, 0
    v_mov_b32 v105, 0
    v_mov_b32 v106, 0
    v_mov_b32 v107, 0
    v_mov_b32 v108, 0
    v_mov_b32 v109, 0
    v_mov_b32 v110, 0
    v_mov_b32 v111, 0
    v_mov_b32 v112, 0
    v_mov_b32 v113, 0
    v_mov_b32 v114, 0
    v_mov_b32 v115, 0
    v_mov_b32 v116, 0
    v_mov_b32 v117, 0
    v_mov_b32 v118, 0
    v_mov_b32 v119, 0
    v_mov_b32 v120, 0
    v_mov_b32 v121, 0
    v_mov_b32 v122, 0
    v_mov_b32 v123, 0
    v_mov_b32 v124, 0
    v_mov_b32 v125, 0
    v_mov_b32 v126, 0
    v_mov_b32 v127, 0
    v_mov_b32 v128, 0
    v_mov_b32 v129, 0
    v_mov_b32 v130, 0
    v_mov_b32 v131, 0
    v_mov_b32 v132, 0
    v_mov_b32 v133, 0
    v_mov_b32 v134, 0
    v_mov_b32 v135, 0
    v_mov_b32 v136, 0
    v_mov_b32 v137, 0
    v_mov_b32 v138, 0
    v_mov_b32 v139, 0
    v_mov_b32 v140, 0
    v_mov_b32 v141, 0
    v_mov_b32 v142, 0
    v_mov_b32 v143, 0
    v_mov_b32 v144, 0
    v_mov_b32 v145, 0
    v_mov_b32 v146, 0
    v_mov_b32 v147, 0
    v_mov_b32 v148, 0
    v_mov_b32 v149, 0
    v_mov_b32 v150, 0
    v_mov_b32 v151, 0
    v_mov_b32 v152, 0
    v_mov_b32 v153, 0
    v_mov_b32 v154, 0
    v_mov_b32 v155, 0
    v_mov_b32 v156, 0
    v_mov_b32 v157, 0
    v_mov_b32 v158, 0
    v_mov_b32 v159, 0
    v_mov_b32 v160, 0
    v_mov_b32 v161, 0
    v_mov_b32 v162, 0
    v_mov_b32 v163, 0
    v_mov_b32 v164, 0
    v_mov_b32 v165, 0
    v_mov_b32 v166, 0
    v_mov_b32 v167, 0
    v_mov_b32 v168, 0
    v_mov_b32 v169, 0
    v_mov_b32 v170, 0
    v_mov_b32 v171, 0
    v_mov_b32 v172, 0
    v_mov_b32 v173, 0
    v_mov_b32 v174, 0
    v_mov_b32 v175, 0
    v_mov_b32 v176, 0
    v_mov_b32 v177, 0
    v_mov_b32 v178, 0
    v_mov_b32 v179, 0
    v_mov_b32 v180, 0
    v_mov_b32 v181, 0
    v_mov_b32 v182, 0
    v_mov_b32 v183, 0
    v_mov_b32 v184, 0
    v_mov_b32 v185, 0
    v_mov_b32 v186, 0
    v_mov_b32 v187, 0
    v_mov_b32 v188, 0
    v_mov_b32 v189, 0
    v_mov_b32 v190, 0
    v_mov_b32 v191, 0
    v_mov_b32 v192, 0
    v_mov_b32 v193, 0
    v_mov_b32 v194, 0
    v_mov_b32 v195, 0
    v_mov_b32 v196, 0
    v_mov_b32 v197, 0
    v_mov_b32 v198, 0
    v_mov_b32 v199, 0
    v_mov_b32 v200, 0
    v_mov_b32 v201, 0
    v_mov_b32 v202, 0
    v_mov_b32 v203, 0
    v_mov_b32 v204, 0
    v_mov_b32 v205, 0
    v_mov_b32 v206, 0
    v_mov_b32 v207, 0
    v_mov_b32 v208, 0
    v_mov_b32 v209, 0
    v_mov_b32 v210, 0
    v_mov_b32 v211, 0
    v_mov_b32 v212, 0
    v_mov_b32 v213, 0
    v_mov_b32 v214, 0
    v_mov_b32 v215, 0
    v_mov_b32 v216, 0
    v_mov_b32 v217, 0
    v_mov_b32 v218, 0
    v_mov_b32 v219, 0
    v_mov_b32 v220, 0
    v_mov_b32 v221, 0
    v_mov_b32 v222, 0
    v_mov_b32 v223, 0
    v_mov_b32 v224, 0
    v_mov_b32 v225, 0
    v_mov_b32 v226, 0
    v_mov_b32 v227, 0
    v_mov_b32 v228, 0
    v_mov_b32 v229, 0
    v_mov_b32 v230, 0
    v_mov_b32 v231, 0
    v_mov_b32 v232, 0
    v_mov_b32 v233, 0
    v_mov_b32 v234, 0
    v_mov_b32 v235, 0
    v_mov_b32 v236, 0
    v_mov_b32 v237, 0
    v_mov_b32 v238, 0
    v_mov_b32 v239, 0
    v_mov_b32 v240, 0
    v_mov_b32 v241, 0
    s_waitcnt lgkmcnt(0)
    s_barrier
    s_cmp_lg_u32 s48, 2
    s_cbranch_scc1 parallel_sum__softmax_full_mha__glu_gated_reglu__prompt_kernel_mainQ
    ds_read_b128 v[66:69], v12 offset:0
    ds_read_b128 v[70:73], v12 offset:4096
    ds_read_b64_tr_b16 v[26:27], v16 offset:0
    ds_read_b64_tr_b16 v[28:29], v16 offset:1024
    ds_read_b64_tr_b16 v[30:31], v17 offset:0
    ds_read_b64_tr_b16 v[32:33], v17 offset:1024
    ds_read_b64_tr_b16 v[34:35], v18 offset:0
    ds_read_b64_tr_b16 v[36:37], v18 offset:768
    ds_read_b64_tr_b16 v[38:39], v18 offset:32
    ds_read_b64_tr_b16 v[40:41], v18 offset:800
    ds_read_b64_tr_b16 v[42:43], v18 offset:64
    ds_read_b64_tr_b16 v[44:45], v18 offset:832
    s_waitcnt lgkmcnt(0)
.p2align 3
parallel_sum__softmax_full_mha__glu_gated_reglu__prompt_kernel_loopA:
    v_mfma_f32_32x32x16_bf16 v[82:97], v[66:69], v[26:29], v[82:97]
    ds_read_b128 v[74:77], v13 offset:0
    ds_read_b128 v[78:81], v13 offset:4096
    v_mfma_f32_32x32x16_bf16 v[162:177], v[70:73], v[26:29], v[162:177]
    ds_read_b64_tr_b16 v[46:47], v16 offset:4096
    ds_read_b64_tr_b16 v[48:49], v16 offset:5120
    v_mfma_f32_32x32x16_bf16 v[98:113], v[66:69], v[30:33], v[98:113]
    ds_read_b64_tr_b16 v[50:51], v17 offset:4096
    ds_read_b64_tr_b16 v[52:53], v17 offset:5120
    v_mfma_f32_32x32x16_bf16 v[178:193], v[70:73], v[30:33], v[178:193]
    ds_read_b64_tr_b16 v[54:55], v18 offset:3072
    ds_read_b64_tr_b16 v[56:57], v18 offset:3840
    v_mfma_f32_32x32x16_bf16 v[114:129], v[34:37], v[66:69], v[114:129]
    ds_read_b64_tr_b16 v[58:59], v18 offset:3104
    ds_read_b64_tr_b16 v[60:61], v18 offset:3872
    v_mfma_f32_32x32x16_bf16 v[194:209], v[34:37], v[70:73], v[194:209]
    ds_read_b64_tr_b16 v[62:63], v18 offset:3136
    ds_read_b64_tr_b16 v[64:65], v18 offset:3904
    v_mfma_f32_32x32x16_bf16 v[130:145], v[38:41], v[66:69], v[130:145]
    v_mfma_f32_32x32x16_bf16 v[210:225], v[38:41], v[70:73], v[210:225]
    v_mfma_f32_32x32x16_bf16 v[146:161], v[42:45], v[66:69], v[146:161]
    s_waitcnt lgkmcnt(0)
    v_mfma_f32_32x32x16_bf16 v[226:241], v[42:45], v[70:73], v[226:241]
    s_barrier
    v_mfma_f32_32x32x16_bf16 v[82:97], v[74:77], v[46:49], v[82:97]
    ds_read_b128 v[66:69], v14 offset:0
    ds_read_b128 v[70:73], v14 offset:4096
    v_mfma_f32_32x32x16_bf16 v[162:177], v[78:81], v[46:49], v[162:177]
    ds_read_b64_tr_b16 v[26:27], v16 offset:20512
    ds_read_b64_tr_b16 v[28:29], v16 offset:21536
    v_mfma_f32_32x32x16_bf16 v[98:113], v[74:77], v[50:53], v[98:113]
    ds_read_b64_tr_b16 v[30:31], v17 offset:20512
    ds_read_b64_tr_b16 v[32:33], v17 offset:21536
    v_mfma_f32_32x32x16_bf16 v[178:193], v[78:81], v[50:53], v[178:193]
    ds_read_b64_tr_b16 v[34:35], v18 offset:20512
    ds_read_b64_tr_b16 v[36:37], v18 offset:21280
    v_mfma_f32_32x32x16_bf16 v[114:129], v[54:57], v[74:77], v[114:129]
    ds_read_b64_tr_b16 v[38:39], v18 offset:20544
    ds_read_b64_tr_b16 v[40:41], v18 offset:21312
    v_mfma_f32_32x32x16_bf16 v[194:209], v[54:57], v[78:81], v[194:209]
    ds_read_b64_tr_b16 v[42:43], v18 offset:20576
    ds_read_b64_tr_b16 v[44:45], v18 offset:21344
    v_mfma_f32_32x32x16_bf16 v[130:145], v[58:61], v[74:77], v[130:145]
    v_mfma_f32_32x32x16_bf16 v[210:225], v[58:61], v[78:81], v[210:225]
    v_mfma_f32_32x32x16_bf16 v[146:161], v[62:65], v[74:77], v[146:161]
    s_waitcnt lgkmcnt(0)
    v_mfma_f32_32x32x16_bf16 v[226:241], v[62:65], v[78:81], v[226:241]
    v_mfma_f32_32x32x16_bf16 v[82:97], v[66:69], v[26:29], v[82:97]
    ds_read_b128 v[74:77], v15 offset:0
    ds_read_b128 v[78:81], v15 offset:4096
    v_mfma_f32_32x32x16_bf16 v[162:177], v[70:73], v[26:29], v[162:177]
    ds_read_b64_tr_b16 v[46:47], v16 offset:24608
    ds_read_b64_tr_b16 v[48:49], v16 offset:25632
    v_mfma_f32_32x32x16_bf16 v[98:113], v[66:69], v[30:33], v[98:113]
    ds_read_b64_tr_b16 v[50:51], v17 offset:24608
    ds_read_b64_tr_b16 v[52:53], v17 offset:25632
    v_mfma_f32_32x32x16_bf16 v[178:193], v[70:73], v[30:33], v[178:193]
    ds_read_b64_tr_b16 v[54:55], v18 offset:23584
    ds_read_b64_tr_b16 v[56:57], v18 offset:24352
    v_mfma_f32_32x32x16_bf16 v[114:129], v[34:37], v[66:69], v[114:129]
    ds_read_b64_tr_b16 v[58:59], v18 offset:23616
    ds_read_b64_tr_b16 v[60:61], v18 offset:24384
    v_mfma_f32_32x32x16_bf16 v[194:209], v[34:37], v[70:73], v[194:209]
    ds_read_b64_tr_b16 v[62:63], v18 offset:23648
    ds_read_b64_tr_b16 v[64:65], v18 offset:24416
    v_mfma_f32_32x32x16_bf16 v[130:145], v[38:41], v[66:69], v[130:145]
    v_mfma_f32_32x32x16_bf16 v[210:225], v[38:41], v[70:73], v[210:225]
    v_mfma_f32_32x32x16_bf16 v[146:161], v[42:45], v[66:69], v[146:161]
    s_waitcnt lgkmcnt(0)
    v_mfma_f32_32x32x16_bf16 v[226:241], v[42:45], v[70:73], v[226:241]
    s_barrier
    v_mfma_f32_32x32x16_bf16 v[82:97], v[74:77], v[46:49], v[82:97]
    ds_read_b128 v[66:69], v12 offset:16384
    ds_read_b128 v[70:73], v12 offset:20480
    v_mfma_f32_32x32x16_bf16 v[162:177], v[78:81], v[46:49], v[162:177]
    ds_read_b64_tr_b16 v[26:27], v19 offset:0
    ds_read_b64_tr_b16 v[28:29], v19 offset:1024
    v_mfma_f32_32x32x16_bf16 v[98:113], v[74:77], v[50:53], v[98:113]
    ds_read_b64_tr_b16 v[30:31], v20 offset:0
    ds_read_b64_tr_b16 v[32:33], v20 offset:1024
    v_mfma_f32_32x32x16_bf16 v[178:193], v[78:81], v[50:53], v[178:193]
    ds_read_b64_tr_b16 v[34:35], v21 offset:0
    ds_read_b64_tr_b16 v[36:37], v21 offset:768
    v_mfma_f32_32x32x16_bf16 v[114:129], v[54:57], v[74:77], v[114:129]
    ds_read_b64_tr_b16 v[38:39], v21 offset:32
    ds_read_b64_tr_b16 v[40:41], v21 offset:800
    v_mfma_f32_32x32x16_bf16 v[194:209], v[54:57], v[78:81], v[194:209]
    ds_read_b64_tr_b16 v[42:43], v21 offset:64
    ds_read_b64_tr_b16 v[44:45], v21 offset:832
    v_mfma_f32_32x32x16_bf16 v[130:145], v[58:61], v[74:77], v[130:145]
    v_mfma_f32_32x32x16_bf16 v[210:225], v[58:61], v[78:81], v[210:225]
    v_mfma_f32_32x32x16_bf16 v[146:161], v[62:65], v[74:77], v[146:161]
    s_waitcnt lgkmcnt(0)
    v_mfma_f32_32x32x16_bf16 v[226:241], v[62:65], v[78:81], v[226:241]
    s_cmp_lg_u32 s41, 2
    s_cbranch_scc1 parallel_sum__softmax_full_mha__glu_gated_reglu__prompt_kernel_loopA_np
    s_getpc_b64 s[56:57]
.Lpc_parallel_sum__softmax_full_mha__glu_gated_reglu__prompt_kernel_post_1714:
    s_add_u32 s56, s56, parallel_sum__softmax_full_mha__glu_gated_reglu__prompt_kernel_post-.Lpc_parallel_sum__softmax_full_mha__glu_gated_reglu__prompt_kernel_post_1714
    s_addc_u32 s57, s57, (parallel_sum__softmax_full_mha__glu_gated_reglu__prompt_kernel_post-.Lpc_parallel_sum__softmax_full_mha__glu_gated_reglu__prompt_kernel_post_1714)>>32
    s_mov_b32 s58, parallel_sum__softmax_full_mha__glu_gated_reglu__prompt_kernel_end-parallel_sum__softmax_full_mha__glu_gated_reglu__prompt_kernel_post
    s_mov_b32 s59, 0x20000
    s_lshl_b32 s33, s32, 13
    v_lshlrev_b32 v249, 3, v1
    buffer_load_dword v248, v249, s[56:59], s33 offen
parallel_sum__softmax_full_mha__glu_gated_reglu__prompt_kernel_loopA_np:
    v_mfma_f32_32x32x16_bf16 v[82:97], v[66:69], v[26:29], v[82:97]
    ds_read_b128 v[74:77], v13 offset:16384
    ds_read_b128 v[78:81], v13 offset:20480
    v_mfma_f32_32x32x16_bf16 v[162:177], v[70:73], v[26:29], v[162:177]
    ds_read_b64_tr_b16 v[46:47], v19 offset:4096
    ds_read_b64_tr_b16 v[48:49], v19 offset:5120
    v_mfma_f32_32x32x16_bf16 v[98:113], v[66:69], v[30:33], v[98:113]
    ds_read_b64_tr_b16 v[50:51], v20 offset:4096
    ds_read_b64_tr_b16 v[52:53], v20 offset:5120
    v_mfma_f32_32x32x16_bf16 v[178:193], v[70:73], v[30:33], v[178:193]
    ds_read_b64_tr_b16 v[54:55], v21 offset:3072
    ds_read_b64_tr_b16 v[56:57], v21 offset:3840
    v_mfma_f32_32x32x16_bf16 v[114:129], v[34:37], v[66:69], v[114:129]
    ds_read_b64_tr_b16 v[58:59], v21 offset:3104
    ds_read_b64_tr_b16 v[60:61], v21 offset:3872
    v_mfma_f32_32x32x16_bf16 v[194:209], v[34:37], v[70:73], v[194:209]
    ds_read_b64_tr_b16 v[62:63], v21 offset:3136
    ds_read_b64_tr_b16 v[64:65], v21 offset:3904
    v_mfma_f32_32x32x16_bf16 v[130:145], v[38:41], v[66:69], v[130:145]
    v_mfma_f32_32x32x16_bf16 v[210:225], v[38:41], v[70:73], v[210:225]
    v_mfma_f32_32x32x16_bf16 v[146:161], v[42:45], v[66:69], v[146:161]
    s_waitcnt lgkmcnt(0)
    v_mfma_f32_32x32x16_bf16 v[226:241], v[42:45], v[70:73], v[226:241]
    s_barrier
    v_mfma_f32_32x32x16_bf16 v[82:97], v[74:77], v[46:49], v[82:97]
    ds_read_b128 v[66:69], v14 offset:16384
    ds_read_b128 v[70:73], v14 offset:20480
    v_mfma_f32_32x32x16_bf16 v[162:177], v[78:81], v[46:49], v[162:177]
    ds_read_b64_tr_b16 v[26:27], v19 offset:20512
    ds_read_b64_tr_b16 v[28:29], v19 offset:21536
    v_mfma_f32_32x32x16_bf16 v[98:113], v[74:77], v[50:53], v[98:113]
    ds_read_b64_tr_b16 v[30:31], v20 offset:20512
    ds_read_b64_tr_b16 v[32:33], v20 offset:21536
    v_mfma_f32_32x32x16_bf16 v[178:193], v[78:81], v[50:53], v[178:193]
    ds_read_b64_tr_b16 v[34:35], v21 offset:20512
    ds_read_b64_tr_b16 v[36:37], v21 offset:21280
    v_mfma_f32_32x32x16_bf16 v[114:129], v[54:57], v[74:77], v[114:129]
    ds_read_b64_tr_b16 v[38:39], v21 offset:20544
    ds_read_b64_tr_b16 v[40:41], v21 offset:21312
    v_mfma_f32_32x32x16_bf16 v[194:209], v[54:57], v[78:81], v[194:209]
    ds_read_b64_tr_b16 v[42:43], v21 offset:20576
    ds_read_b64_tr_b16 v[44:45], v21 offset:21344
    v_mfma_f32_32x32x16_bf16 v[130:145], v[58:61], v[74:77], v[130:145]
    v_mfma_f32_32x32x16_bf16 v[210:225], v[58:61], v[78:81], v[210:225]
    v_mfma_f32_32x32x16_bf16 v[146:161], v[62:65], v[74:77], v[146:161]
    s_waitcnt lgkmcnt(0)
    v_mfma_f32_32x32x16_bf16 v[226:241], v[62:65], v[78:81], v[226:241]
    v_mfma_f32_32x32x16_bf16 v[82:97], v[66:69], v[26:29], v[82:97]
    ds_read_b128 v[74:77], v15 offset:16384
    ds_read_b128 v[78:81], v15 offset:20480
    v_mfma_f32_32x32x16_bf16 v[162:177], v[70:73], v[26:29], v[162:177]
    ds_read_b64_tr_b16 v[46:47], v19 offset:24608
    ds_read_b64_tr_b16 v[48:49], v19 offset:25632
    v_mfma_f32_32x32x16_bf16 v[98:113], v[66:69], v[30:33], v[98:113]
    ds_read_b64_tr_b16 v[50:51], v20 offset:24608
    ds_read_b64_tr_b16 v[52:53], v20 offset:25632
    v_mfma_f32_32x32x16_bf16 v[178:193], v[70:73], v[30:33], v[178:193]
    ds_read_b64_tr_b16 v[54:55], v21 offset:23584
    ds_read_b64_tr_b16 v[56:57], v21 offset:24352
    v_mfma_f32_32x32x16_bf16 v[114:129], v[34:37], v[66:69], v[114:129]
    ds_read_b64_tr_b16 v[58:59], v21 offset:23616
    ds_read_b64_tr_b16 v[60:61], v21 offset:24384
    v_mfma_f32_32x32x16_bf16 v[194:209], v[34:37], v[70:73], v[194:209]
    ds_read_b64_tr_b16 v[62:63], v21 offset:23648
    ds_read_b64_tr_b16 v[64:65], v21 offset:24416
    v_mfma_f32_32x32x16_bf16 v[130:145], v[38:41], v[66:69], v[130:145]
    v_mfma_f32_32x32x16_bf16 v[210:225], v[38:41], v[70:73], v[210:225]
    v_mfma_f32_32x32x16_bf16 v[146:161], v[42:45], v[66:69], v[146:161]
    s_waitcnt lgkmcnt(0)
    v_mfma_f32_32x32x16_bf16 v[226:241], v[42:45], v[70:73], v[226:241]
    s_barrier
    v_mfma_f32_32x32x16_bf16 v[82:97], v[74:77], v[46:49], v[82:97]
    ds_read_b128 v[66:69], v12 offset:0
    ds_read_b128 v[70:73], v12 offset:4096
    v_mfma_f32_32x32x16_bf16 v[162:177], v[78:81], v[46:49], v[162:177]
    ds_read_b64_tr_b16 v[26:27], v16 offset:0
    ds_read_b64_tr_b16 v[28:29], v16 offset:1024
    v_mfma_f32_32x32x16_bf16 v[98:113], v[74:77], v[50:53], v[98:113]
    ds_read_b64_tr_b16 v[30:31], v17 offset:0
    ds_read_b64_tr_b16 v[32:33], v17 offset:1024
    v_mfma_f32_32x32x16_bf16 v[178:193], v[78:81], v[50:53], v[178:193]
    ds_read_b64_tr_b16 v[34:35], v18 offset:0
    ds_read_b64_tr_b16 v[36:37], v18 offset:768
    v_mfma_f32_32x32x16_bf16 v[114:129], v[54:57], v[74:77], v[114:129]
    ds_read_b64_tr_b16 v[38:39], v18 offset:32
    ds_read_b64_tr_b16 v[40:41], v18 offset:800
    v_mfma_f32_32x32x16_bf16 v[194:209], v[54:57], v[78:81], v[194:209]
    ds_read_b64_tr_b16 v[42:43], v18 offset:64
    ds_read_b64_tr_b16 v[44:45], v18 offset:832
    v_mfma_f32_32x32x16_bf16 v[130:145], v[58:61], v[74:77], v[130:145]
    v_mfma_f32_32x32x16_bf16 v[210:225], v[58:61], v[78:81], v[210:225]
    v_mfma_f32_32x32x16_bf16 v[146:161], v[62:65], v[74:77], v[146:161]
    s_waitcnt lgkmcnt(0)
    s_sub_u32 s41, s41, 1
    s_cmp_lg_u32 s41, 0
    v_mfma_f32_32x32x16_bf16 v[226:241], v[62:65], v[78:81], v[226:241]
    s_cbranch_scc1 parallel_sum__softmax_full_mha__glu_gated_reglu__prompt_kernel_loopA
    s_branch parallel_sum__softmax_full_mha__glu_gated_reglu__prompt_kernel_post
parallel_sum__softmax_full_mha__glu_gated_reglu__prompt_kernel_mainQ:
    ds_read_b128 v[66:69], v12 offset:0
    ds_read_b128 v[70:73], v12 offset:4096
    ds_read_b64_tr_b16 v[26:27], v16 offset:0
    ds_read_b64_tr_b16 v[28:29], v16 offset:1024
    ds_read_b64_tr_b16 v[30:31], v17 offset:0
    ds_read_b64_tr_b16 v[32:33], v17 offset:1024
    ds_read_b64_tr_b16 v[34:35], v18 offset:0
    ds_read_b64_tr_b16 v[36:37], v18 offset:768
    ds_read_b64_tr_b16 v[38:39], v18 offset:32
    ds_read_b64_tr_b16 v[40:41], v18 offset:800
    ds_read_b64_tr_b16 v[42:43], v18 offset:64
    ds_read_b64_tr_b16 v[44:45], v18 offset:832
    s_waitcnt lgkmcnt(0)
.p2align 3
parallel_sum__softmax_full_mha__glu_gated_reglu__prompt_kernel_loopQ:
    v_mfma_f32_32x32x16_bf16 v[82:97], v[26:29], v[66:69], v[82:97]
    ds_read_b128 v[74:77], v13 offset:0
    ds_read_b128 v[78:81], v13 offset:4096
    v_mfma_f32_32x32x16_bf16 v[162:177], v[26:29], v[70:73], v[162:177]
    ds_read_b64_tr_b16 v[46:47], v16 offset:4096
    ds_read_b64_tr_b16 v[48:49], v16 offset:5120
    v_mfma_f32_32x32x16_bf16 v[98:113], v[30:33], v[66:69], v[98:113]
    ds_read_b64_tr_b16 v[50:51], v17 offset:4096
    ds_read_b64_tr_b16 v[52:53], v17 offset:5120
    v_mfma_f32_32x32x16_bf16 v[178:193], v[30:33], v[70:73], v[178:193]
    ds_read_b64_tr_b16 v[54:55], v18 offset:3072
    ds_read_b64_tr_b16 v[56:57], v18 offset:3840
    v_mfma_f32_32x32x16_bf16 v[114:129], v[34:37], v[66:69], v[114:129]
    ds_read_b64_tr_b16 v[58:59], v18 offset:3104
    ds_read_b64_tr_b16 v[60:61], v18 offset:3872
    v_mfma_f32_32x32x16_bf16 v[194:209], v[34:37], v[70:73], v[194:209]
    ds_read_b64_tr_b16 v[62:63], v18 offset:3136
    ds_read_b64_tr_b16 v[64:65], v18 offset:3904
    v_mfma_f32_32x32x16_bf16 v[130:145], v[38:41], v[66:69], v[130:145]
    v_mfma_f32_32x32x16_bf16 v[210:225], v[38:41], v[70:73], v[210:225]
    v_mfma_f32_32x32x16_bf16 v[146:161], v[42:45], v[66:69], v[146:161]
    s_waitcnt lgkmcnt(0)
    v_mfma_f32_32x32x16_bf16 v[226:241], v[42:45], v[70:73], v[226:241]
    s_barrier
    v_mfma_f32_32x32x16_bf16 v[82:97], v[46:49], v[74:77], v[82:97]
    ds_read_b128 v[66:69], v14 offset:0
    ds_read_b128 v[70:73], v14 offset:4096
    v_mfma_f32_32x32x16_bf16 v[162:177], v[46:49], v[78:81], v[162:177]
    ds_read_b64_tr_b16 v[26:27], v16 offset:20512
    ds_read_b64_tr_b16 v[28:29], v16 offset:21536
    v_mfma_f32_32x32x16_bf16 v[98:113], v[50:53], v[74:77], v[98:113]
    ds_read_b64_tr_b16 v[30:31], v17 offset:20512
    ds_read_b64_tr_b16 v[32:33], v17 offset:21536
    v_mfma_f32_32x32x16_bf16 v[178:193], v[50:53], v[78:81], v[178:193]
    ds_read_b64_tr_b16 v[34:35], v18 offset:20512
    ds_read_b64_tr_b16 v[36:37], v18 offset:21280
    v_mfma_f32_32x32x16_bf16 v[114:129], v[54:57], v[74:77], v[114:129]
    ds_read_b64_tr_b16 v[38:39], v18 offset:20544
    ds_read_b64_tr_b16 v[40:41], v18 offset:21312
    v_mfma_f32_32x32x16_bf16 v[194:209], v[54:57], v[78:81], v[194:209]
    ds_read_b64_tr_b16 v[42:43], v18 offset:20576
    ds_read_b64_tr_b16 v[44:45], v18 offset:21344
    v_mfma_f32_32x32x16_bf16 v[130:145], v[58:61], v[74:77], v[130:145]
    v_mfma_f32_32x32x16_bf16 v[210:225], v[58:61], v[78:81], v[210:225]
    v_mfma_f32_32x32x16_bf16 v[146:161], v[62:65], v[74:77], v[146:161]
    s_waitcnt lgkmcnt(0)
    v_mfma_f32_32x32x16_bf16 v[226:241], v[62:65], v[78:81], v[226:241]
    v_mfma_f32_32x32x16_bf16 v[82:97], v[26:29], v[66:69], v[82:97]
    ds_read_b128 v[74:77], v15 offset:0
    ds_read_b128 v[78:81], v15 offset:4096
    v_mfma_f32_32x32x16_bf16 v[162:177], v[26:29], v[70:73], v[162:177]
    ds_read_b64_tr_b16 v[46:47], v16 offset:24608
    ds_read_b64_tr_b16 v[48:49], v16 offset:25632
    v_mfma_f32_32x32x16_bf16 v[98:113], v[30:33], v[66:69], v[98:113]
    ds_read_b64_tr_b16 v[50:51], v17 offset:24608
    ds_read_b64_tr_b16 v[52:53], v17 offset:25632
    v_mfma_f32_32x32x16_bf16 v[178:193], v[30:33], v[70:73], v[178:193]
    ds_read_b64_tr_b16 v[54:55], v18 offset:23584
    ds_read_b64_tr_b16 v[56:57], v18 offset:24352
    v_mfma_f32_32x32x16_bf16 v[114:129], v[34:37], v[66:69], v[114:129]
    ds_read_b64_tr_b16 v[58:59], v18 offset:23616
    ds_read_b64_tr_b16 v[60:61], v18 offset:24384
    v_mfma_f32_32x32x16_bf16 v[194:209], v[34:37], v[70:73], v[194:209]
    ds_read_b64_tr_b16 v[62:63], v18 offset:23648
    ds_read_b64_tr_b16 v[64:65], v18 offset:24416
    v_mfma_f32_32x32x16_bf16 v[130:145], v[38:41], v[66:69], v[130:145]
    v_mfma_f32_32x32x16_bf16 v[210:225], v[38:41], v[70:73], v[210:225]
    v_mfma_f32_32x32x16_bf16 v[146:161], v[42:45], v[66:69], v[146:161]
    s_waitcnt lgkmcnt(0)
    v_mfma_f32_32x32x16_bf16 v[226:241], v[42:45], v[70:73], v[226:241]
    s_barrier
    v_mfma_f32_32x32x16_bf16 v[82:97], v[46:49], v[74:77], v[82:97]
    ds_read_b128 v[66:69], v12 offset:16384
    ds_read_b128 v[70:73], v12 offset:20480
    v_mfma_f32_32x32x16_bf16 v[162:177], v[46:49], v[78:81], v[162:177]
    ds_read_b64_tr_b16 v[26:27], v19 offset:0
    ds_read_b64_tr_b16 v[28:29], v19 offset:1024
    v_mfma_f32_32x32x16_bf16 v[98:113], v[50:53], v[74:77], v[98:113]
    ds_read_b64_tr_b16 v[30:31], v20 offset:0
    ds_read_b64_tr_b16 v[32:33], v20 offset:1024
    v_mfma_f32_32x32x16_bf16 v[178:193], v[50:53], v[78:81], v[178:193]
    ds_read_b64_tr_b16 v[34:35], v21 offset:0
    ds_read_b64_tr_b16 v[36:37], v21 offset:768
    v_mfma_f32_32x32x16_bf16 v[114:129], v[54:57], v[74:77], v[114:129]
    ds_read_b64_tr_b16 v[38:39], v21 offset:32
    ds_read_b64_tr_b16 v[40:41], v21 offset:800
    v_mfma_f32_32x32x16_bf16 v[194:209], v[54:57], v[78:81], v[194:209]
    ds_read_b64_tr_b16 v[42:43], v21 offset:64
    ds_read_b64_tr_b16 v[44:45], v21 offset:832
    v_mfma_f32_32x32x16_bf16 v[130:145], v[58:61], v[74:77], v[130:145]
    v_mfma_f32_32x32x16_bf16 v[210:225], v[58:61], v[78:81], v[210:225]
    v_mfma_f32_32x32x16_bf16 v[146:161], v[62:65], v[74:77], v[146:161]
    s_waitcnt lgkmcnt(0)
    v_mfma_f32_32x32x16_bf16 v[226:241], v[62:65], v[78:81], v[226:241]
    s_cmp_lg_u32 s41, 2
    s_cbranch_scc1 parallel_sum__softmax_full_mha__glu_gated_reglu__prompt_kernel_loopQ_np
    s_getpc_b64 s[56:57]
.Lpc_parallel_sum__softmax_full_mha__glu_gated_reglu__prompt_kernel_post_1934:
    s_add_u32 s56, s56, parallel_sum__softmax_full_mha__glu_gated_reglu__prompt_kernel_post-.Lpc_parallel_sum__softmax_full_mha__glu_gated_reglu__prompt_kernel_post_1934
    s_addc_u32 s57, s57, (parallel_sum__softmax_full_mha__glu_gated_reglu__prompt_kernel_post-.Lpc_parallel_sum__softmax_full_mha__glu_gated_reglu__prompt_kernel_post_1934)>>32
    s_mov_b32 s58, parallel_sum__softmax_full_mha__glu_gated_reglu__prompt_kernel_end-parallel_sum__softmax_full_mha__glu_gated_reglu__prompt_kernel_post
    s_mov_b32 s59, 0x20000
    s_lshl_b32 s33, s32, 13
    v_lshlrev_b32 v249, 3, v1
    buffer_load_dword v248, v249, s[56:59], s33 offen
parallel_sum__softmax_full_mha__glu_gated_reglu__prompt_kernel_loopQ_np:
    v_mfma_f32_32x32x16_bf16 v[82:97], v[26:29], v[66:69], v[82:97]
    ds_read_b128 v[74:77], v13 offset:16384
    ds_read_b128 v[78:81], v13 offset:20480
    v_mfma_f32_32x32x16_bf16 v[162:177], v[26:29], v[70:73], v[162:177]
    ds_read_b64_tr_b16 v[46:47], v19 offset:4096
    ds_read_b64_tr_b16 v[48:49], v19 offset:5120
    v_mfma_f32_32x32x16_bf16 v[98:113], v[30:33], v[66:69], v[98:113]
    ds_read_b64_tr_b16 v[50:51], v20 offset:4096
    ds_read_b64_tr_b16 v[52:53], v20 offset:5120
    v_mfma_f32_32x32x16_bf16 v[178:193], v[30:33], v[70:73], v[178:193]
    ds_read_b64_tr_b16 v[54:55], v21 offset:3072
    ds_read_b64_tr_b16 v[56:57], v21 offset:3840
    v_mfma_f32_32x32x16_bf16 v[114:129], v[34:37], v[66:69], v[114:129]
    ds_read_b64_tr_b16 v[58:59], v21 offset:3104
    ds_read_b64_tr_b16 v[60:61], v21 offset:3872
    v_mfma_f32_32x32x16_bf16 v[194:209], v[34:37], v[70:73], v[194:209]
    ds_read_b64_tr_b16 v[62:63], v21 offset:3136
    ds_read_b64_tr_b16 v[64:65], v21 offset:3904
    v_mfma_f32_32x32x16_bf16 v[130:145], v[38:41], v[66:69], v[130:145]
    v_mfma_f32_32x32x16_bf16 v[210:225], v[38:41], v[70:73], v[210:225]
    v_mfma_f32_32x32x16_bf16 v[146:161], v[42:45], v[66:69], v[146:161]
    s_waitcnt lgkmcnt(0)
    v_mfma_f32_32x32x16_bf16 v[226:241], v[42:45], v[70:73], v[226:241]
    s_barrier
    v_mfma_f32_32x32x16_bf16 v[82:97], v[46:49], v[74:77], v[82:97]
    ds_read_b128 v[66:69], v14 offset:16384
    ds_read_b128 v[70:73], v14 offset:20480
    v_mfma_f32_32x32x16_bf16 v[162:177], v[46:49], v[78:81], v[162:177]
    ds_read_b64_tr_b16 v[26:27], v19 offset:20512
    ds_read_b64_tr_b16 v[28:29], v19 offset:21536
    v_mfma_f32_32x32x16_bf16 v[98:113], v[50:53], v[74:77], v[98:113]
    ds_read_b64_tr_b16 v[30:31], v20 offset:20512
    ds_read_b64_tr_b16 v[32:33], v20 offset:21536
    v_mfma_f32_32x32x16_bf16 v[178:193], v[50:53], v[78:81], v[178:193]
    ds_read_b64_tr_b16 v[34:35], v21 offset:20512
    ds_read_b64_tr_b16 v[36:37], v21 offset:21280
    v_mfma_f32_32x32x16_bf16 v[114:129], v[54:57], v[74:77], v[114:129]
    ds_read_b64_tr_b16 v[38:39], v21 offset:20544
    ds_read_b64_tr_b16 v[40:41], v21 offset:21312
    v_mfma_f32_32x32x16_bf16 v[194:209], v[54:57], v[78:81], v[194:209]
    ds_read_b64_tr_b16 v[42:43], v21 offset:20576
    ds_read_b64_tr_b16 v[44:45], v21 offset:21344
    v_mfma_f32_32x32x16_bf16 v[130:145], v[58:61], v[74:77], v[130:145]
    v_mfma_f32_32x32x16_bf16 v[210:225], v[58:61], v[78:81], v[210:225]
    v_mfma_f32_32x32x16_bf16 v[146:161], v[62:65], v[74:77], v[146:161]
    s_waitcnt lgkmcnt(0)
    v_mfma_f32_32x32x16_bf16 v[226:241], v[62:65], v[78:81], v[226:241]
    v_mfma_f32_32x32x16_bf16 v[82:97], v[26:29], v[66:69], v[82:97]
    ds_read_b128 v[74:77], v15 offset:16384
    ds_read_b128 v[78:81], v15 offset:20480
    v_mfma_f32_32x32x16_bf16 v[162:177], v[26:29], v[70:73], v[162:177]
    ds_read_b64_tr_b16 v[46:47], v19 offset:24608
    ds_read_b64_tr_b16 v[48:49], v19 offset:25632
    v_mfma_f32_32x32x16_bf16 v[98:113], v[30:33], v[66:69], v[98:113]
    ds_read_b64_tr_b16 v[50:51], v20 offset:24608
    ds_read_b64_tr_b16 v[52:53], v20 offset:25632
    v_mfma_f32_32x32x16_bf16 v[178:193], v[30:33], v[70:73], v[178:193]
    ds_read_b64_tr_b16 v[54:55], v21 offset:23584
    ds_read_b64_tr_b16 v[56:57], v21 offset:24352
    v_mfma_f32_32x32x16_bf16 v[114:129], v[34:37], v[66:69], v[114:129]
    ds_read_b64_tr_b16 v[58:59], v21 offset:23616
    ds_read_b64_tr_b16 v[60:61], v21 offset:24384
    v_mfma_f32_32x32x16_bf16 v[194:209], v[34:37], v[70:73], v[194:209]
    ds_read_b64_tr_b16 v[62:63], v21 offset:23648
    ds_read_b64_tr_b16 v[64:65], v21 offset:24416
    v_mfma_f32_32x32x16_bf16 v[130:145], v[38:41], v[66:69], v[130:145]
    v_mfma_f32_32x32x16_bf16 v[210:225], v[38:41], v[70:73], v[210:225]
    v_mfma_f32_32x32x16_bf16 v[146:161], v[42:45], v[66:69], v[146:161]
    s_waitcnt lgkmcnt(0)
    v_mfma_f32_32x32x16_bf16 v[226:241], v[42:45], v[70:73], v[226:241]
    s_barrier
    v_mfma_f32_32x32x16_bf16 v[82:97], v[46:49], v[74:77], v[82:97]
    ds_read_b128 v[66:69], v12 offset:0
    ds_read_b128 v[70:73], v12 offset:4096
    v_mfma_f32_32x32x16_bf16 v[162:177], v[46:49], v[78:81], v[162:177]
    ds_read_b64_tr_b16 v[26:27], v16 offset:0
    ds_read_b64_tr_b16 v[28:29], v16 offset:1024
    v_mfma_f32_32x32x16_bf16 v[98:113], v[50:53], v[74:77], v[98:113]
    ds_read_b64_tr_b16 v[30:31], v17 offset:0
    ds_read_b64_tr_b16 v[32:33], v17 offset:1024
    v_mfma_f32_32x32x16_bf16 v[178:193], v[50:53], v[78:81], v[178:193]
    ds_read_b64_tr_b16 v[34:35], v18 offset:0
    ds_read_b64_tr_b16 v[36:37], v18 offset:768
    v_mfma_f32_32x32x16_bf16 v[114:129], v[54:57], v[74:77], v[114:129]
    ds_read_b64_tr_b16 v[38:39], v18 offset:32
    ds_read_b64_tr_b16 v[40:41], v18 offset:800
    v_mfma_f32_32x32x16_bf16 v[194:209], v[54:57], v[78:81], v[194:209]
    ds_read_b64_tr_b16 v[42:43], v18 offset:64
    ds_read_b64_tr_b16 v[44:45], v18 offset:832
    v_mfma_f32_32x32x16_bf16 v[130:145], v[58:61], v[74:77], v[130:145]
    v_mfma_f32_32x32x16_bf16 v[210:225], v[58:61], v[78:81], v[210:225]
    v_mfma_f32_32x32x16_bf16 v[146:161], v[62:65], v[74:77], v[146:161]
    s_waitcnt lgkmcnt(0)
    s_sub_u32 s41, s41, 1
    s_cmp_lg_u32 s41, 0
    v_mfma_f32_32x32x16_bf16 v[226:241], v[62:65], v[78:81], v[226:241]
    s_cbranch_scc1 parallel_sum__softmax_full_mha__glu_gated_reglu__prompt_kernel_loopQ
parallel_sum__softmax_full_mha__glu_gated_reglu__prompt_kernel_post:
    s_barrier
    v_lshlrev_b32 v3, 2, v6
    s_lshl_b32 s33, s31, 8
    v_add_u32 v5, s33, v3
    ds_read_b32 v26, v5 offset:0
    ds_read_b32 v30, v5 offset:512
    ds_read_b32 v28, v5 offset:128
    ds_read_b32 v32, v5 offset:640
    s_lshl_b32 s33, s28, 2
    s_lshl_b32 s52, s31, 1
    s_add_u32 s52, s52, s33
    s_add_u32 s53, s52, 1
    v_mov_b32 v2, 0
    ds_read_b64 v[8:9], v2 offset:2304
    s_cmp_eq_u32 s48, 3
    s_cbranch_scc1 parallel_sum__softmax_full_mha__glu_gated_reglu__prompt_kernel_e1x
    s_cmp_eq_u32 s48, 2
    s_cbranch_scc1 parallel_sum__softmax_full_mha__glu_gated_reglu__prompt_kernel_e1v
    s_lshl_b32 s33, s30, 8
    v_lshlrev_b32 v2, 4, v7
    v_add_u32 v4, s33, v2
    ds_read_b128 v[34:37], v4 offset:1024
    ds_read_b128 v[38:41], v4 offset:1056
    ds_read_b128 v[42:45], v4 offset:1088
    ds_read_b128 v[46:49], v4 offset:1120
    s_cmp_eq_u32 s48, 1
    s_movk_i32 s54, 1280
    s_cselect_b32 s54, 2688, s54
    s_cselect_b32 s34, 2621440, 0
    s_cselect_b32 s57, 1.0, 0x3ea52b5c
    s_lshl_b32 s55, s54, 6
    s_mul_i32 s58, s52, s54
    s_add_u32 s58, s58, s34
    s_mul_i32 s59, s53, s54
    s_add_u32 s59, s59, s34
    s_lshl_b32 s56, s39, 4
    s_lshl_b32 s33, s30, 3
    s_add_u32 s56, s56, s33
    v_mul_lo_u32 v3, v7, s54
    v_lshl_add_u32 v20, v6, 4, v3
    v_mul_lo_u32 v3, v7, s55
    v_lshl_add_u32 v21, v6, 3, v3
    s_waitcnt lgkmcnt(0)
    v_pk_fma_f32 v[82:83], v[34:35], v[26:27], v[82:83] op_sel_hi:[1,0,1]
    v_pk_fma_f32 v[84:85], v[36:37], v[26:27], v[84:85] op_sel_hi:[1,0,1]
    v_pk_fma_f32 v[86:87], v[38:39], v[26:27], v[86:87] op_sel_hi:[1,0,1]
    v_pk_fma_f32 v[88:89], v[40:41], v[26:27], v[88:89] op_sel_hi:[1,0,1]
    v_pk_fma_f32 v[90:91], v[42:43], v[26:27], v[90:91] op_sel_hi:[1,0,1]
    v_pk_fma_f32 v[92:93], v[44:45], v[26:27], v[92:93] op_sel_hi:[1,0,1]
    v_pk_fma_f32 v[94:95], v[46:47], v[26:27], v[94:95] op_sel_hi:[1,0,1]
    v_pk_fma_f32 v[96:97], v[48:49], v[26:27], v[96:97] op_sel_hi:[1,0,1]
    v_pk_fma_f32 v[162:163], v[34:35], v[28:29], v[162:163] op_sel_hi:[1,0,1]
    v_pk_fma_f32 v[164:165], v[36:37], v[28:29], v[164:165] op_sel_hi:[1,0,1]
    v_pk_fma_f32 v[166:167], v[38:39], v[28:29], v[166:167] op_sel_hi:[1,0,1]
    v_pk_fma_f32 v[168:169], v[40:41], v[28:29], v[168:169] op_sel_hi:[1,0,1]
    v_pk_fma_f32 v[170:171], v[42:43], v[28:29], v[170:171] op_sel_hi:[1,0,1]
    v_pk_fma_f32 v[172:173], v[44:45], v[28:29], v[172:173] op_sel_hi:[1,0,1]
    v_pk_fma_f32 v[174:175], v[46:47], v[28:29], v[174:175] op_sel_hi:[1,0,1]
    v_pk_fma_f32 v[176:177], v[48:49], v[28:29], v[176:177] op_sel_hi:[1,0,1]
    ds_read_b128 v[34:37], v4 offset:1152
    ds_read_b128 v[38:41], v4 offset:1184
    ds_read_b128 v[42:45], v4 offset:1216
    ds_read_b128 v[46:49], v4 offset:1248
    v_mul_f32 v58, s57, v30
    v_pk_mul_f32 v[82:83], v[82:83], v[58:59] op_sel_hi:[1,0]
    v_pk_mul_f32 v[84:85], v[84:85], v[58:59] op_sel_hi:[1,0]
    v_pk_mul_f32 v[86:87], v[86:87], v[58:59] op_sel_hi:[1,0]
    v_pk_mul_f32 v[88:89], v[88:89], v[58:59] op_sel_hi:[1,0]
    v_pk_mul_f32 v[90:91], v[90:91], v[58:59] op_sel_hi:[1,0]
    v_pk_mul_f32 v[92:93], v[92:93], v[58:59] op_sel_hi:[1,0]
    v_pk_mul_f32 v[94:95], v[94:95], v[58:59] op_sel_hi:[1,0]
    v_pk_mul_f32 v[96:97], v[96:97], v[58:59] op_sel_hi:[1,0]
    v_mul_f32 v58, s57, v32
    v_pk_mul_f32 v[162:163], v[162:163], v[58:59] op_sel_hi:[1,0]
    v_pk_mul_f32 v[164:165], v[164:165], v[58:59] op_sel_hi:[1,0]
    v_pk_mul_f32 v[166:167], v[166:167], v[58:59] op_sel_hi:[1,0]
    v_pk_mul_f32 v[168:169], v[168:169], v[58:59] op_sel_hi:[1,0]
    v_pk_mul_f32 v[170:171], v[170:171], v[58:59] op_sel_hi:[1,0]
    v_pk_mul_f32 v[172:173], v[172:173], v[58:59] op_sel_hi:[1,0]
    v_pk_mul_f32 v[174:175], v[174:175], v[58:59] op_sel_hi:[1,0]
    v_pk_mul_f32 v[176:177], v[176:177], v[58:59] op_sel_hi:[1,0]
    v_cvt_pk_bf16_f32 v82, v82, v83
    v_cvt_pk_bf16_f32 v83, v84, v85
    v_cvt_pk_bf16_f32 v84, v162, v163
    v_cvt_pk_bf16_f32 v85, v164, v165
    v_cvt_pk_bf16_f32 v86, v86, v87
    v_cvt_pk_bf16_f32 v87, v88, v89
    v_cvt_pk_bf16_f32 v88, v166, v167
    v_cvt_pk_bf16_f32 v89, v168, v169
    v_cvt_pk_bf16_f32 v90, v90, v91
    v_cvt_pk_bf16_f32 v91, v92, v93
    v_cvt_pk_bf16_f32 v92, v170, v171
    v_cvt_pk_bf16_f32 v93, v172, v173
    v_cvt_pk_bf16_f32 v94, v94, v95
    v_cvt_pk_bf16_f32 v95, v96, v97
    v_cvt_pk_bf16_f32 v96, v174, v175
    v_cvt_pk_bf16_f32 v97, v176, v177
    v_dot2_f32_bf16 v162, v82, v82, 0
    v_dot2_f32_bf16 v163, v84, v84, 0
    v_dot2_f32_bf16 v164, v86, v86, 0
    v_dot2_f32_bf16 v165, v88, v88, 0
    v_dot2_f32_bf16 v166, v90, v90, 0
    v_dot2_f32_bf16 v167, v92, v92, 0
    v_dot2_f32_bf16 v168, v94, v94, 0
    v_dot2_f32_bf16 v169, v96, v96, 0
    v_dot2c_f32_bf16 v162, v83, v83
    v_dot2c_f32_bf16 v163, v85, v85
    v_dot2c_f32_bf16 v164, v87, v87
    v_dot2c_f32_bf16 v165, v89, v89
    v_dot2c_f32_bf16 v166, v91, v91
    v_dot2c_f32_bf16 v167, v93, v93
    v_dot2c_f32_bf16 v168, v95, v95
    v_dot2c_f32_bf16 v169, v97, v97
    s_add_u32 s33, s56, 0
    s_mul_i32 s34, s33, 13108
    s_lshr_b32 s34, s34, 16
    s_mul_i32 s46, s34, 5
    s_sub_u32 s33, s33, s46
    s_lshl_b32 s34, s34, 1
    s_mul_i32 s46, s34, s55
    s_cmp_eq_u32 s33, 2
    s_cbranch_scc1 parallel_sum__softmax_full_mha__glu_gated_reglu__prompt_kernel_sp00
    v_permlane32_swap_b32 v82, v84
    v_permlane32_swap_b32 v83, v85
    s_sub_u32 s47, s55, 1536
    s_cmp_ge_u32 s33, 3
    s_cselect_b32 s47, s47, 0
    s_lshl_b32 s33, s33, 9
    s_add_u32 s46, s46, s47
    s_add_u32 s46, s46, s33
    s_add_u32 s46, s46, s58
    buffer_store_dwordx4 v[82:85], v20, s[60:63], s46 offen sc1
    s_branch parallel_sum__softmax_full_mha__glu_gated_reglu__prompt_kernel_it00
parallel_sum__softmax_full_mha__glu_gated_reglu__prompt_kernel_sp00:
    s_add_u32 s47, s46, s58
    buffer_store_dwordx2 v[82:83], v21, s[60:63], s47 offen offset:1024 sc1
    s_add_u32 s47, s46, s59
    buffer_store_dwordx2 v[84:85], v21, s[60:63], s47 offen offset:1024 sc1
parallel_sum__softmax_full_mha__glu_gated_reglu__prompt_kernel_it00:
    s_add_u32 s33, s56, 1
    s_mul_i32 s34, s33, 13108
    s_lshr_b32 s34, s34, 16
    s_mul_i32 s46, s34, 5
    s_sub_u32 s33, s33, s46
    s_lshl_b32 s34, s34, 1
    s_mul_i32 s46, s34, s55
    s_cmp_eq_u32 s33, 2
    s_cbranch_scc1 parallel_sum__softmax_full_mha__glu_gated_reglu__prompt_kernel_sp01
    v_permlane32_swap_b32 v86, v88
    v_permlane32_swap_b32 v87, v89
    s_sub_u32 s47, s55, 1536
    s_cmp_ge_u32 s33, 3
    s_cselect_b32 s47, s47, 0
    s_lshl_b32 s33, s33, 9
    s_add_u32 s46, s46, s47
    s_add_u32 s46, s46, s33
    s_add_u32 s46, s46, s58
    buffer_store_dwordx4 v[86:89], v20, s[60:63], s46 offen sc1
    s_branch parallel_sum__softmax_full_mha__glu_gated_reglu__prompt_kernel_it01
parallel_sum__softmax_full_mha__glu_gated_reglu__prompt_kernel_sp01:
    s_add_u32 s47, s46, s58
    buffer_store_dwordx2 v[86:87], v21, s[60:63], s47 offen offset:1024 sc1
    s_add_u32 s47, s46, s59
    buffer_store_dwordx2 v[88:89], v21, s[60:63], s47 offen offset:1024 sc1
parallel_sum__softmax_full_mha__glu_gated_reglu__prompt_kernel_it01:
    s_add_u32 s33, s56, 2
    s_mul_i32 s34, s33, 13108
    s_lshr_b32 s34, s34, 16
    s_mul_i32 s46, s34, 5
    s_sub_u32 s33, s33, s46
    s_lshl_b32 s34, s34, 1
    s_mul_i32 s46, s34, s55
    s_cmp_eq_u32 s33, 2
    s_cbranch_scc1 parallel_sum__softmax_full_mha__glu_gated_reglu__prompt_kernel_sp02
    v_permlane32_swap_b32 v90, v92
    v_permlane32_swap_b32 v91, v93
    s_sub_u32 s47, s55, 1536
    s_cmp_ge_u32 s33, 3
    s_cselect_b32 s47, s47, 0
    s_lshl_b32 s33, s33, 9
    s_add_u32 s46, s46, s47
    s_add_u32 s46, s46, s33
    s_add_u32 s46, s46, s58
    buffer_store_dwordx4 v[90:93], v20, s[60:63], s46 offen sc1
    s_branch parallel_sum__softmax_full_mha__glu_gated_reglu__prompt_kernel_it02
parallel_sum__softmax_full_mha__glu_gated_reglu__prompt_kernel_sp02:
    s_add_u32 s47, s46, s58
    buffer_store_dwordx2 v[90:91], v21, s[60:63], s47 offen offset:1024 sc1
    s_add_u32 s47, s46, s59
    buffer_store_dwordx2 v[92:93], v21, s[60:63], s47 offen offset:1024 sc1
parallel_sum__softmax_full_mha__glu_gated_reglu__prompt_kernel_it02:
    s_add_u32 s33, s56, 3
    s_mul_i32 s34, s33, 13108
    s_lshr_b32 s34, s34, 16
    s_mul_i32 s46, s34, 5
    s_sub_u32 s33, s33, s46
    s_lshl_b32 s34, s34, 1
    s_mul_i32 s46, s34, s55
    s_cmp_eq_u32 s33, 2
    s_cbranch_scc1 parallel_sum__softmax_full_mha__glu_gated_reglu__prompt_kernel_sp03
    v_permlane32_swap_b32 v94, v96
    v_permlane32_swap_b32 v95, v97
    s_sub_u32 s47, s55, 1536
    s_cmp_ge_u32 s33, 3
    s_cselect_b32 s47, s47, 0
    s_lshl_b32 s33, s33, 9
    s_add_u32 s46, s46, s47
    s_add_u32 s46, s46, s33
    s_add_u32 s46, s46, s58
    buffer_store_dwordx4 v[94:97], v20, s[60:63], s46 offen sc1
    s_branch parallel_sum__softmax_full_mha__glu_gated_reglu__prompt_kernel_it03
parallel_sum__softmax_full_mha__glu_gated_reglu__prompt_kernel_sp03:
    s_add_u32 s47, s46, s58
    buffer_store_dwordx2 v[94:95], v21, s[60:63], s47 offen offset:1024 sc1
    s_add_u32 s47, s46, s59
    buffer_store_dwordx2 v[96:97], v21, s[60:63], s47 offen offset:1024 sc1
parallel_sum__softmax_full_mha__glu_gated_reglu__prompt_kernel_it03:
    s_waitcnt lgkmcnt(0)
    v_pk_fma_f32 v[98:99], v[34:35], v[26:27], v[98:99] op_sel_hi:[1,0,1]
    v_pk_fma_f32 v[100:101], v[36:37], v[26:27], v[100:101] op_sel_hi:[1,0,1]
    v_pk_fma_f32 v[102:103], v[38:39], v[26:27], v[102:103] op_sel_hi:[1,0,1]
    v_pk_fma_f32 v[104:105], v[40:41], v[26:27], v[104:105] op_sel_hi:[1,0,1]
    v_pk_fma_f32 v[106:107], v[42:43], v[26:27], v[106:107] op_sel_hi:[1,0,1]
    v_pk_fma_f32 v[108:109], v[44:45], v[26:27], v[108:109] op_sel_hi:[1,0,1]
    v_pk_fma_f32 v[110:111], v[46:47], v[26:27], v[110:111] op_sel_hi:[1,0,1]
    v_pk_fma_f32 v[112:113], v[48:49], v[26:27], v[112:113] op_sel_hi:[1,0,1]
    v_pk_fma_f32 v[178:179], v[34:35], v[28:29], v[178:179] op_sel_hi:[1,0,1]
    v_pk_fma_f32 v[180:181], v[36:37], v[28:29], v[180:181] op_sel_hi:[1,0,1]
    v_pk_fma_f32 v[182:183], v[38:39], v[28:29], v[182:183] op_sel_hi:[1,0,1]
    v_pk_fma_f32 v[184:185], v[40:41], v[28:29], v[184:185] op_sel_hi:[1,0,1]
    v_pk_fma_f32 v[186:187], v[42:43], v[28:29], v[186:187] op_sel_hi:[1,0,1]
    v_pk_fma_f32 v[188:189], v[44:45], v[28:29], v[188:189] op_sel_hi:[1,0,1]
    v_pk_fma_f32 v[190:191], v[46:47], v[28:29], v[190:191] op_sel_hi:[1,0,1]
    v_pk_fma_f32 v[192:193], v[48:49], v[28:29], v[192:193] op_sel_hi:[1,0,1]
    v_mul_f32 v58, s57, v30
    v_pk_mul_f32 v[98:99], v[98:99], v[58:59] op_sel_hi:[1,0]
    v_pk_mul_f32 v[100:101], v[100:101], v[58:59] op_sel_hi:[1,0]
    v_pk_mul_f32 v[102:103], v[102:103], v[58:59] op_sel_hi:[1,0]
    v_pk_mul_f32 v[104:105], v[104:105], v[58:59] op_sel_hi:[1,0]
    v_pk_mul_f32 v[106:107], v[106:107], v[58:59] op_sel_hi:[1,0]
    v_pk_mul_f32 v[108:109], v[108:109], v[58:59] op_sel_hi:[1,0]
    v_pk_mul_f32 v[110:111], v[110:111], v[58:59] op_sel_hi:[1,0]
    v_pk_mul_f32 v[112:113], v[112:113], v[58:59] op_sel_hi:[1,0]
    v_mul_f32 v58, s57, v32
    v_pk_mul_f32 v[178:179], v[178:179], v[58:59] op_sel_hi:[1,0]
    v_pk_mul_f32 v[180:181], v[180:181], v[58:59] op_sel_hi:[1,0]
    v_pk_mul_f32 v[182:183], v[182:183], v[58:59] op_sel_hi:[1,0]
    v_pk_mul_f32 v[184:185], v[184:185], v[58:59] op_sel_hi:[1,0]
    v_pk_mul_f32 v[186:187], v[186:187], v[58:59] op_sel_hi:[1,0]
    v_pk_mul_f32 v[188:189], v[188:189], v[58:59] op_sel_hi:[1,0]
    v_pk_mul_f32 v[190:191], v[190:191], v[58:59] op_sel_hi:[1,0]
    v_pk_mul_f32 v[192:193], v[192:193], v[58:59] op_sel_hi:[1,0]
    v_cvt_pk_bf16_f32 v98, v98, v99
    v_cvt_pk_bf16_f32 v99, v100, v101
    v_cvt_pk_bf16_f32 v100, v178, v179
    v_cvt_pk_bf16_f32 v101, v180, v181
    v_cvt_pk_bf16_f32 v102, v102, v103
    v_cvt_pk_bf16_f32 v103, v104, v105
    v_cvt_pk_bf16_f32 v104, v182, v183
    v_cvt_pk_bf16_f32 v105, v184, v185
    v_cvt_pk_bf16_f32 v106, v106, v107
    v_cvt_pk_bf16_f32 v107, v108, v109
    v_cvt_pk_bf16_f32 v108, v186, v187
    v_cvt_pk_bf16_f32 v109, v188, v189
    v_cvt_pk_bf16_f32 v110, v110, v111
    v_cvt_pk_bf16_f32 v111, v112, v113
    v_cvt_pk_bf16_f32 v112, v190, v191
    v_cvt_pk_bf16_f32 v113, v192, v193
    v_dot2_f32_bf16 v178, v98, v98, 0
    v_dot2_f32_bf16 v179, v100, v100, 0
    v_dot2_f32_bf16 v180, v102, v102, 0
    v_dot2_f32_bf16 v181, v104, v104, 0
    v_dot2_f32_bf16 v182, v106, v106, 0
    v_dot2_f32_bf16 v183, v108, v108, 0
    v_dot2_f32_bf16 v184, v110, v110, 0
    v_dot2_f32_bf16 v185, v112, v112, 0
    v_dot2c_f32_bf16 v178, v99, v99
    v_dot2c_f32_bf16 v179, v101, v101
    v_dot2c_f32_bf16 v180, v103, v103
    v_dot2c_f32_bf16 v181, v105, v105
    v_dot2c_f32_bf16 v182, v107, v107
    v_dot2c_f32_bf16 v183, v109, v109
    v_dot2c_f32_bf16 v184, v111, v111
    v_dot2c_f32_bf16 v185, v113, v113
    s_add_u32 s33, s56, 4
    s_mul_i32 s34, s33, 13108
    s_lshr_b32 s34, s34, 16
    s_mul_i32 s46, s34, 5
    s_sub_u32 s33, s33, s46
    s_lshl_b32 s34, s34, 1
    s_mul_i32 s46, s34, s55
    s_cmp_eq_u32 s33, 2
    s_cbranch_scc1 parallel_sum__softmax_full_mha__glu_gated_reglu__prompt_kernel_sp10
    v_permlane32_swap_b32 v98, v100
    v_permlane32_swap_b32 v99, v101
    s_sub_u32 s47, s55, 1536
    s_cmp_ge_u32 s33, 3
    s_cselect_b32 s47, s47, 0
    s_lshl_b32 s33, s33, 9
    s_add_u32 s46, s46, s47
    s_add_u32 s46, s46, s33
    s_add_u32 s46, s46, s58
    buffer_store_dwordx4 v[98:101], v20, s[60:63], s46 offen sc1
    s_branch parallel_sum__softmax_full_mha__glu_gated_reglu__prompt_kernel_it10
parallel_sum__softmax_full_mha__glu_gated_reglu__prompt_kernel_sp10:
    s_add_u32 s47, s46, s58
    buffer_store_dwordx2 v[98:99], v21, s[60:63], s47 offen offset:1024 sc1
    s_add_u32 s47, s46, s59
    buffer_store_dwordx2 v[100:101], v21, s[60:63], s47 offen offset:1024 sc1
parallel_sum__softmax_full_mha__glu_gated_reglu__prompt_kernel_it10:
    s_add_u32 s33, s56, 5
    s_mul_i32 s34, s33, 13108
    s_lshr_b32 s34, s34, 16
    s_mul_i32 s46, s34, 5
    s_sub_u32 s33, s33, s46
    s_lshl_b32 s34, s34, 1
    s_mul_i32 s46, s34, s55
    s_cmp_eq_u32 s33, 2
    s_cbranch_scc1 parallel_sum__softmax_full_mha__glu_gated_reglu__prompt_kernel_sp11
    v_permlane32_swap_b32 v102, v104
    v_permlane32_swap_b32 v103, v105
    s_sub_u32 s47, s55, 1536
    s_cmp_ge_u32 s33, 3
    s_cselect_b32 s47, s47, 0
    s_lshl_b32 s33, s33, 9
    s_add_u32 s46, s46, s47
    s_add_u32 s46, s46, s33
    s_add_u32 s46, s46, s58
    buffer_store_dwordx4 v[102:105], v20, s[60:63], s46 offen sc1
    s_branch parallel_sum__softmax_full_mha__glu_gated_reglu__prompt_kernel_it11
parallel_sum__softmax_full_mha__glu_gated_reglu__prompt_kernel_sp11:
    s_add_u32 s47, s46, s58
    buffer_store_dwordx2 v[102:103], v21, s[60:63], s47 offen offset:1024 sc1
    s_add_u32 s47, s46, s59
    buffer_store_dwordx2 v[104:105], v21, s[60:63], s47 offen offset:1024 sc1
parallel_sum__softmax_full_mha__glu_gated_reglu__prompt_kernel_it11:
    s_add_u32 s33, s56, 6
    s_mul_i32 s34, s33, 13108
    s_lshr_b32 s34, s34, 16
    s_mul_i32 s46, s34, 5
    s_sub_u32 s33, s33, s46
    s_lshl_b32 s34, s34, 1
    s_mul_i32 s46, s34, s55
    s_cmp_eq_u32 s33, 2
    s_cbranch_scc1 parallel_sum__softmax_full_mha__glu_gated_reglu__prompt_kernel_sp12
    v_permlane32_swap_b32 v106, v108
    v_permlane32_swap_b32 v107, v109
    s_sub_u32 s47, s55, 1536
    s_cmp_ge_u32 s33, 3
    s_cselect_b32 s47, s47, 0
    s_lshl_b32 s33, s33, 9
    s_add_u32 s46, s46, s47
    s_add_u32 s46, s46, s33
    s_add_u32 s46, s46, s58
    buffer_store_dwordx4 v[106:109], v20, s[60:63], s46 offen sc1
    s_branch parallel_sum__softmax_full_mha__glu_gated_reglu__prompt_kernel_it12
parallel_sum__softmax_full_mha__glu_gated_reglu__prompt_kernel_sp12:
    s_add_u32 s47, s46, s58
    buffer_store_dwordx2 v[106:107], v21, s[60:63], s47 offen offset:1024 sc1
    s_add_u32 s47, s46, s59
    buffer_store_dwordx2 v[108:109], v21, s[60:63], s47 offen offset:1024 sc1
parallel_sum__softmax_full_mha__glu_gated_reglu__prompt_kernel_it12:
    s_add_u32 s33, s56, 7
    s_mul_i32 s34, s33, 13108
    s_lshr_b32 s34, s34, 16
    s_mul_i32 s46, s34, 5
    s_sub_u32 s33, s33, s46
    s_lshl_b32 s34, s34, 1
    s_mul_i32 s46, s34, s55
    s_cmp_eq_u32 s33, 2
    s_cbranch_scc1 parallel_sum__softmax_full_mha__glu_gated_reglu__prompt_kernel_sp13
    v_permlane32_swap_b32 v110, v112
    v_permlane32_swap_b32 v111, v113
    s_sub_u32 s47, s55, 1536
    s_cmp_ge_u32 s33, 3
    s_cselect_b32 s47, s47, 0
    s_lshl_b32 s33, s33, 9
    s_add_u32 s46, s46, s47
    s_add_u32 s46, s46, s33
    s_add_u32 s46, s46, s58
    buffer_store_dwordx4 v[110:113], v20, s[60:63], s46 offen sc1
    s_branch parallel_sum__softmax_full_mha__glu_gated_reglu__prompt_kernel_it13
parallel_sum__softmax_full_mha__glu_gated_reglu__prompt_kernel_sp13:
    s_add_u32 s47, s46, s58
    buffer_store_dwordx2 v[110:111], v21, s[60:63], s47 offen offset:1024 sc1
    s_add_u32 s47, s46, s59
    buffer_store_dwordx2 v[112:113], v21, s[60:63], s47 offen offset:1024 sc1
parallel_sum__softmax_full_mha__glu_gated_reglu__prompt_kernel_it13:
    s_cmp_eq_u32 s48, 0
    s_cbranch_scc1 parallel_sum__softmax_full_mha__glu_gated_reglu__prompt_kernel_e1x
    v_and_b32 v2, 1, v0
    v_cmp_eq_u32 s[46:47], 0, v2
    v_and_b32 v2, 2, v0
    v_cmp_eq_u32 s[48:49], 0, v2
    v_cndmask_b32 v170, v162, v163, s[46:47]
    v_cndmask_b32 v162, v163, v162, s[46:47]
    v_cndmask_b32 v172, v164, v165, s[46:47]
    v_cndmask_b32 v164, v165, v164, s[46:47]
    v_cndmask_b32 v174, v166, v167, s[46:47]
    v_cndmask_b32 v166, v167, v166, s[46:47]
    v_cndmask_b32 v176, v168, v169, s[46:47]
    v_cndmask_b32 v168, v169, v168, s[46:47]
    v_cndmask_b32 v186, v178, v179, s[46:47]
    v_cndmask_b32 v178, v179, v178, s[46:47]
    v_cndmask_b32 v188, v180, v181, s[46:47]
    v_cndmask_b32 v180, v181, v180, s[46:47]
    v_cndmask_b32 v190, v182, v183, s[46:47]
    v_cndmask_b32 v182, v183, v182, s[46:47]
    v_cndmask_b32 v192, v184, v185, s[46:47]
    v_cndmask_b32 v184, v185, v184, s[46:47]
    v_max_f32_dpp v162, v170, v162 quad_perm:[1,0,3,2] row_mask:0xf bank_mask:0xf
    v_max_f32_dpp v164, v172, v164 quad_perm:[1,0,3,2] row_mask:0xf bank_mask:0xf
    v_max_f32_dpp v166, v174, v166 quad_perm:[1,0,3,2] row_mask:0xf bank_mask:0xf
    v_max_f32_dpp v168, v176, v168 quad_perm:[1,0,3,2] row_mask:0xf bank_mask:0xf
    v_max_f32_dpp v178, v186, v178 quad_perm:[1,0,3,2] row_mask:0xf bank_mask:0xf
    v_max_f32_dpp v180, v188, v180 quad_perm:[1,0,3,2] row_mask:0xf bank_mask:0xf
    v_max_f32_dpp v182, v190, v182 quad_perm:[1,0,3,2] row_mask:0xf bank_mask:0xf
    v_max_f32_dpp v184, v192, v184 quad_perm:[1,0,3,2] row_mask:0xf bank_mask:0xf
    v_cndmask_b32 v170, v162, v178, s[48:49]
    v_cndmask_b32 v162, v178, v162, s[48:49]
    v_cndmask_b32 v172, v164, v180, s[48:49]
    v_cndmask_b32 v164, v180, v164, s[48:49]
    v_cndmask_b32 v174, v166, v182, s[48:49]
    v_cndmask_b32 v166, v182, v166, s[48:49]
    v_cndmask_b32 v176, v168, v184, s[48:49]
    v_cndmask_b32 v168, v184, v168, s[48:49]
    v_max_f32_dpp v162, v170, v162 quad_perm:[2,3,0,1] row_mask:0xf bank_mask:0xf
    v_max_f32_dpp v164, v172, v164 quad_perm:[2,3,0,1] row_mask:0xf bank_mask:0xf
    v_max_f32_dpp v166, v174, v166 quad_perm:[2,3,0,1] row_mask:0xf bank_mask:0xf
    v_max_f32_dpp v168, v176, v168 quad_perm:[2,3,0,1] row_mask:0xf bank_mask:0xf
    v_max_f32_dpp v162, v162, v162 row_ror:4 row_mask:0xf bank_mask:0xf
    v_max_f32_dpp v164, v164, v164 row_ror:4 row_mask:0xf bank_mask:0xf
    v_max_f32_dpp v166, v166, v166 row_ror:4 row_mask:0xf bank_mask:0xf
    v_max_f32_dpp v168, v168, v168 row_ror:4 row_mask:0xf bank_mask:0xf
    v_max_f32_dpp v162, v162, v162 row_ror:8 row_mask:0xf bank_mask:0xf
    v_max_f32_dpp v164, v164, v164 row_ror:8 row_mask:0xf bank_mask:0xf
    v_max_f32_dpp v166, v166, v166 row_ror:8 row_mask:0xf bank_mask:0xf
    v_max_f32_dpp v168, v168, v168 row_ror:8 row_mask:0xf bank_mask:0xf
    v_mov_b32 v170, v162
    v_mov_b32 v172, v164
    v_mov_b32 v174, v166
    v_mov_b32 v176, v168
    v_permlane16_swap_b32 v170, v162
    v_permlane16_swap_b32 v172, v164
    v_permlane16_swap_b32 v174, v166
    v_permlane16_swap_b32 v176, v168
    v_max_f32 v162, v162, v170
    v_max_f32 v164, v164, v172
    v_max_f32 v166, v166, v174
    v_max_f32 v168, v168, v176
    v_lshrrev_b32 v2, 2, v6
    v_cmp_eq_u32 vcc, 1, v2
    s_nop 1
    v_cndmask_b32 v162, v162, v164, vcc
    v_cmp_eq_u32 vcc, 2, v2
    s_nop 1
    v_cndmask_b32 v162, v162, v166, vcc
    v_cmp_eq_u32 vcc, 3, v2
    s_nop 1
    v_cndmask_b32 v162, v162, v168, vcc
    v_bfe_u32 v3, v6, 1, 1
    v_lshl_add_u32 v2, v3, 2, v2
    v_add_u32 v2, s56, v2
    v_lshl_add_u32 v2, v2, 1, v7
    v_lshlrev_b32 v2, 8, v2
    v_and_b32 v3, 1, v6
    v_lshl_add_u32 v2, v3, 2, v2
    s_lshl_b32 s33, s52, 2
    s_add_u32 s33, s33, 8142848
    s_mov_b32 exec_lo, 0xffff
    s_mov_b32 exec_hi, 0xffff
    buffer_store_dword v162, v2, s[60:63], s33 offen sc1
    s_mov_b64 exec, -1
    s_branch parallel_sum__softmax_full_mha__glu_gated_reglu__prompt_kernel_e1x
parallel_sum__softmax_full_mha__glu_gated_reglu__prompt_kernel_e1v:
    s_lshl_b32 s33, s30, 8
    v_add_u32 v3, s33, v3
    ds_read_b32 v58, v3 offset:1024
    ds_read_b32 v60, v3 offset:1152
    v_lshlrev_b32 v3, 4, v7
    s_lshl_b32 s33, s31, 8
    v_add_u32 v4, s33, v3
    s_lshl_b32 s33, s39, 7
    s_lshl_b32 s34, s30, 6
    s_add_u32 s33, s33, s34
    s_add_u32 s33, s33, 0
    v_add_u32 v2, s33, v6
    v_mul_u32_u24 v3, 3277, v2
    v_lshrrev_b32 v3, 16, v3
    v_mul_u32_u24 v5, 20, v3
    v_sub_u32 v2, v2, v5
    s_mov_b32 s33, 172032
    v_mul_lo_u32 v3, v3, s33
    v_mul_u32_u24 v5, 320, v7
    v_lshl_add_u32 v5, v2, 4, v5
    v_add_u32 v20, v5, v3
    s_lshl_b32 s33, s39, 7
    s_lshl_b32 s34, s30, 6
    s_add_u32 s33, s33, s34
    s_add_u32 s33, s33, 32
    v_add_u32 v2, s33, v6
    v_mul_u32_u24 v3, 3277, v2
    v_lshrrev_b32 v3, 16, v3
    v_mul_u32_u24 v5, 20, v3
    v_sub_u32 v2, v2, v5
    s_mov_b32 s33, 172032
    v_mul_lo_u32 v3, v3, s33
    v_mul_u32_u24 v5, 320, v7
    v_lshl_add_u32 v5, v2, 4, v5
    v_add_u32 v21, v5, v3
    s_mul_i32 s58, s52, 2688
    s_add_u32 s58, s58, 2621440
    s_mul_i32 s59, s53, 2688
    s_add_u32 s59, s59, 2621440
    ds_read_b128 v[34:37], v4 offset:0
    ds_read_b128 v[38:41], v4 offset:32
    ds_read_b128 v[42:45], v4 offset:64
    ds_read_b128 v[46:49], v4 offset:96
    s_waitcnt lgkmcnt(0)
    v_pk_fma_f32 v[82:83], v[34:35], v[58:59], v[82:83] op_sel_hi:[1,0,1]
    v_pk_fma_f32 v[84:85], v[36:37], v[58:59], v[84:85] op_sel_hi:[1,0,1]
    v_pk_fma_f32 v[86:87], v[38:39], v[58:59], v[86:87] op_sel_hi:[1,0,1]
    v_pk_fma_f32 v[88:89], v[40:41], v[58:59], v[88:89] op_sel_hi:[1,0,1]
    v_pk_fma_f32 v[90:91], v[42:43], v[58:59], v[90:91] op_sel_hi:[1,0,1]
    v_pk_fma_f32 v[92:93], v[44:45], v[58:59], v[92:93] op_sel_hi:[1,0,1]
    v_pk_fma_f32 v[94:95], v[46:47], v[58:59], v[94:95] op_sel_hi:[1,0,1]
    v_pk_fma_f32 v[96:97], v[48:49], v[58:59], v[96:97] op_sel_hi:[1,0,1]
    v_pk_fma_f32 v[98:99], v[34:35], v[60:61], v[98:99] op_sel_hi:[1,0,1]
    v_pk_fma_f32 v[100:101], v[36:37], v[60:61], v[100:101] op_sel_hi:[1,0,1]
    v_pk_fma_f32 v[102:103], v[38:39], v[60:61], v[102:103] op_sel_hi:[1,0,1]
    v_pk_fma_f32 v[104:105], v[40:41], v[60:61], v[104:105] op_sel_hi:[1,0,1]
    v_pk_fma_f32 v[106:107], v[42:43], v[60:61], v[106:107] op_sel_hi:[1,0,1]
    v_pk_fma_f32 v[108:109], v[44:45], v[60:61], v[108:109] op_sel_hi:[1,0,1]
    v_pk_fma_f32 v[110:111], v[46:47], v[60:61], v[110:111] op_sel_hi:[1,0,1]
    v_pk_fma_f32 v[112:113], v[48:49], v[60:61], v[112:113] op_sel_hi:[1,0,1]
    ds_read_b128 v[34:37], v4 offset:512
    ds_read_b128 v[38:41], v4 offset:544
    ds_read_b128 v[42:45], v4 offset:576
    ds_read_b128 v[46:49], v4 offset:608
    s_waitcnt lgkmcnt(0)
    v_pk_mul_f32 v[82:83], v[82:83], v[34:35]
    v_pk_mul_f32 v[84:85], v[84:85], v[36:37]
    v_pk_mul_f32 v[86:87], v[86:87], v[38:39]
    v_pk_mul_f32 v[88:89], v[88:89], v[40:41]
    v_pk_mul_f32 v[90:91], v[90:91], v[42:43]
    v_pk_mul_f32 v[92:93], v[92:93], v[44:45]
    v_pk_mul_f32 v[94:95], v[94:95], v[46:47]
    v_pk_mul_f32 v[96:97], v[96:97], v[48:49]
    v_pk_mul_f32 v[98:99], v[98:99], v[34:35]
    v_pk_mul_f32 v[100:101], v[100:101], v[36:37]
    v_pk_mul_f32 v[102:103], v[102:103], v[38:39]
    v_pk_mul_f32 v[104:105], v[104:105], v[40:41]
    v_pk_mul_f32 v[106:107], v[106:107], v[42:43]
    v_pk_mul_f32 v[108:109], v[108:109], v[44:45]
    v_pk_mul_f32 v[110:111], v[110:111], v[46:47]
    v_pk_mul_f32 v[112:113], v[112:113], v[48:49]
    v_cvt_pk_bf16_f32 v82, v82, v83
    v_cvt_pk_bf16_f32 v83, v84, v85
    v_cvt_pk_bf16_f32 v84, v86, v87
    v_cvt_pk_bf16_f32 v85, v88, v89
    v_cvt_pk_bf16_f32 v86, v90, v91
    v_cvt_pk_bf16_f32 v87, v92, v93
    v_cvt_pk_bf16_f32 v88, v94, v95
    v_cvt_pk_bf16_f32 v89, v96, v97
    buffer_store_dwordx4 v[82:85], v20, s[60:63], s58 offen offset:1280 sc1
    buffer_store_dwordx4 v[86:89], v20, s[60:63], s58 offen offset:1920 sc1
    v_cvt_pk_bf16_f32 v98, v98, v99
    v_cvt_pk_bf16_f32 v99, v100, v101
    v_cvt_pk_bf16_f32 v100, v102, v103
    v_cvt_pk_bf16_f32 v101, v104, v105
    v_cvt_pk_bf16_f32 v102, v106, v107
    v_cvt_pk_bf16_f32 v103, v108, v109
    v_cvt_pk_bf16_f32 v104, v110, v111
    v_cvt_pk_bf16_f32 v105, v112, v113
    buffer_store_dwordx4 v[98:101], v21, s[60:63], s58 offen offset:1280 sc1
    buffer_store_dwordx4 v[102:105], v21, s[60:63], s58 offen offset:1920 sc1
    ds_read_b128 v[34:37], v4 offset:128
    ds_read_b128 v[38:41], v4 offset:160
    ds_read_b128 v[42:45], v4 offset:192
    ds_read_b128 v[46:49], v4 offset:224
    s_waitcnt lgkmcnt(0)
    v_pk_fma_f32 v[162:163], v[34:35], v[58:59], v[162:163] op_sel_hi:[1,0,1]
    v_pk_fma_f32 v[164:165], v[36:37], v[58:59], v[164:165] op_sel_hi:[1,0,1]
    v_pk_fma_f32 v[166:167], v[38:39], v[58:59], v[166:167] op_sel_hi:[1,0,1]
    v_pk_fma_f32 v[168:169], v[40:41], v[58:59], v[168:169] op_sel_hi:[1,0,1]
    v_pk_fma_f32 v[170:171], v[42:43], v[58:59], v[170:171] op_sel_hi:[1,0,1]
    v_pk_fma_f32 v[172:173], v[44:45], v[58:59], v[172:173] op_sel_hi:[1,0,1]
    v_pk_fma_f32 v[174:175], v[46:47], v[58:59], v[174:175] op_sel_hi:[1,0,1]
    v_pk_fma_f32 v[176:177], v[48:49], v[58:59], v[176:177] op_sel_hi:[1,0,1]
    v_pk_fma_f32 v[178:179], v[34:35], v[60:61], v[178:179] op_sel_hi:[1,0,1]
    v_pk_fma_f32 v[180:181], v[36:37], v[60:61], v[180:181] op_sel_hi:[1,0,1]
    v_pk_fma_f32 v[182:183], v[38:39], v[60:61], v[182:183] op_sel_hi:[1,0,1]
    v_pk_fma_f32 v[184:185], v[40:41], v[60:61], v[184:185] op_sel_hi:[1,0,1]
    v_pk_fma_f32 v[186:187], v[42:43], v[60:61], v[186:187] op_sel_hi:[1,0,1]
    v_pk_fma_f32 v[188:189], v[44:45], v[60:61], v[188:189] op_sel_hi:[1,0,1]
    v_pk_fma_f32 v[190:191], v[46:47], v[60:61], v[190:191] op_sel_hi:[1,0,1]
    v_pk_fma_f32 v[192:193], v[48:49], v[60:61], v[192:193] op_sel_hi:[1,0,1]
    ds_read_b128 v[34:37], v4 offset:640
    ds_read_b128 v[38:41], v4 offset:672
    ds_read_b128 v[42:45], v4 offset:704
    ds_read_b128 v[46:49], v4 offset:736
    s_waitcnt lgkmcnt(0)
    v_pk_mul_f32 v[162:163], v[162:163], v[34:35]
    v_pk_mul_f32 v[164:165], v[164:165], v[36:37]
    v_pk_mul_f32 v[166:167], v[166:167], v[38:39]
    v_pk_mul_f32 v[168:169], v[168:169], v[40:41]
    v_pk_mul_f32 v[170:171], v[170:171], v[42:43]
    v_pk_mul_f32 v[172:173], v[172:173], v[44:45]
    v_pk_mul_f32 v[174:175], v[174:175], v[46:47]
    v_pk_mul_f32 v[176:177], v[176:177], v[48:49]
    v_pk_mul_f32 v[178:179], v[178:179], v[34:35]
    v_pk_mul_f32 v[180:181], v[180:181], v[36:37]
    v_pk_mul_f32 v[182:183], v[182:183], v[38:39]
    v_pk_mul_f32 v[184:185], v[184:185], v[40:41]
    v_pk_mul_f32 v[186:187], v[186:187], v[42:43]
    v_pk_mul_f32 v[188:189], v[188:189], v[44:45]
    v_pk_mul_f32 v[190:191], v[190:191], v[46:47]
    v_pk_mul_f32 v[192:193], v[192:193], v[48:49]
    v_cvt_pk_bf16_f32 v162, v162, v163
    v_cvt_pk_bf16_f32 v163, v164, v165
    v_cvt_pk_bf16_f32 v164, v166, v167
    v_cvt_pk_bf16_f32 v165, v168, v169
    v_cvt_pk_bf16_f32 v166, v170, v171
    v_cvt_pk_bf16_f32 v167, v172, v173
    v_cvt_pk_bf16_f32 v168, v174, v175
    v_cvt_pk_bf16_f32 v169, v176, v177
    buffer_store_dwordx4 v[162:165], v20, s[60:63], s59 offen offset:1280 sc1
    buffer_store_dwordx4 v[166:169], v20, s[60:63], s59 offen offset:1920 sc1
    v_cvt_pk_bf16_f32 v178, v178, v179
    v_cvt_pk_bf16_f32 v179, v180, v181
    v_cvt_pk_bf16_f32 v180, v182, v183
    v_cvt_pk_bf16_f32 v181, v184, v185
    v_cvt_pk_bf16_f32 v182, v186, v187
    v_cvt_pk_bf16_f32 v183, v188, v189
    v_cvt_pk_bf16_f32 v184, v190, v191
    v_cvt_pk_bf16_f32 v185, v192, v193
    buffer_store_dwordx4 v[178:181], v21, s[60:63], s59 offen offset:1280 sc1
    buffer_store_dwordx4 v[182:185], v21, s[60:63], s59 offen offset:1920 sc1
parallel_sum__softmax_full_mha__glu_gated_reglu__prompt_kernel_e1x:
    s_waitcnt lgkmcnt(0)
    v_readfirstlane_b32 s50, v8
    v_readfirstlane_b32 s51, v9
    s_waitcnt vmcnt(0)
    s_barrier
    s_mul_i32 s33, s30, 384
    v_lshlrev_b32 v2, 4, v7
    v_add_u32 v4, s33, v2
    ds_read_b128 v[34:37], v4 offset:1536
    ds_read_b128 v[38:41], v4 offset:1568
    ds_read_b128 v[42:45], v4 offset:1600
    ds_read_b128 v[46:49], v4 offset:1632
    ds_read_b128 v[50:53], v4 offset:1664
    ds_read_b128 v[54:57], v4 offset:1696
    ds_read_b128 v[58:61], v4 offset:1728
    ds_read_b128 v[62:65], v4 offset:1760
    ds_read_b128 v[66:69], v4 offset:1792
    ds_read_b128 v[70:73], v4 offset:1824
    ds_read_b128 v[74:77], v4 offset:1856
    ds_read_b128 v[78:81], v4 offset:1888
    s_mul_i32 s58, s52, 139264
    s_mul_i32 s59, s53, 139264
    s_mul_i32 s33, s29, 6144
    s_mul_i32 s34, s30, 3072
    s_add_u32 s33, s33, s34
    s_add_u32 s33, s33, 8249344
    s_add_u32 s58, s58, s33
    v_mul_f32 v30, v30, v30
    s_add_u32 s59, s59, s33
    v_mul_f32 v32, v32, v32
    s_waitcnt lgkmcnt(8)
    v_pk_fma_f32 v[114:115], v[34:35], v[26:27], v[114:115] op_sel_hi:[1,0,1]
    v_pk_fma_f32 v[116:117], v[36:37], v[26:27], v[116:117] op_sel_hi:[1,0,1]
    v_pk_fma_f32 v[118:119], v[38:39], v[26:27], v[118:119] op_sel_hi:[1,0,1]
    v_pk_fma_f32 v[120:121], v[40:41], v[26:27], v[120:121] op_sel_hi:[1,0,1]
    v_pk_fma_f32 v[122:123], v[42:43], v[26:27], v[122:123] op_sel_hi:[1,0,1]
    v_pk_fma_f32 v[124:125], v[44:45], v[26:27], v[124:125] op_sel_hi:[1,0,1]
    v_pk_fma_f32 v[126:127], v[46:47], v[26:27], v[126:127] op_sel_hi:[1,0,1]
    v_pk_fma_f32 v[128:129], v[48:49], v[26:27], v[128:129] op_sel_hi:[1,0,1]
    v_max_f32 v114, 0, v114
    v_max_f32 v115, 0, v115
    v_max_f32 v116, 0, v116
    v_max_f32 v117, 0, v117
    v_max_f32 v118, 0, v118
    v_max_f32 v119, 0, v119
    v_max_f32 v120, 0, v120
    v_max_f32 v121, 0, v121
    v_pk_mul_f32 v[122:123], v[122:123], v[30:31] op_sel_hi:[1,0]
    v_pk_mul_f32 v[124:125], v[124:125], v[30:31] op_sel_hi:[1,0]
    v_pk_mul_f32 v[126:127], v[126:127], v[30:31] op_sel_hi:[1,0]
    v_pk_mul_f32 v[128:129], v[128:129], v[30:31] op_sel_hi:[1,0]
    v_pk_mul_f32 v[114:115], v[114:115], v[122:123]
    v_pk_mul_f32 v[116:117], v[116:117], v[124:125]
    v_pk_mul_f32 v[118:119], v[118:119], v[126:127]
    v_pk_mul_f32 v[120:121], v[120:121], v[128:129]
    v_cvt_pk_bf16_f32 v164, v114, v115
    v_cvt_pk_bf16_f32 v165, v116, v117
    v_cvt_pk_bf16_f32 v166, v118, v119
    v_cvt_pk_bf16_f32 v167, v120, v121
    v_pk_fma_f32 v[194:195], v[34:35], v[28:29], v[194:195] op_sel_hi:[1,0,1]
    v_pk_fma_f32 v[196:197], v[36:37], v[28:29], v[196:197] op_sel_hi:[1,0,1]
    v_pk_fma_f32 v[198:199], v[38:39], v[28:29], v[198:199] op_sel_hi:[1,0,1]
    v_pk_fma_f32 v[200:201], v[40:41], v[28:29], v[200:201] op_sel_hi:[1,0,1]
    v_pk_fma_f32 v[202:203], v[42:43], v[28:29], v[202:203] op_sel_hi:[1,0,1]
    v_pk_fma_f32 v[204:205], v[44:45], v[28:29], v[204:205] op_sel_hi:[1,0,1]
    v_pk_fma_f32 v[206:207], v[46:47], v[28:29], v[206:207] op_sel_hi:[1,0,1]
    v_pk_fma_f32 v[208:209], v[48:49], v[28:29], v[208:209] op_sel_hi:[1,0,1]
    v_max_f32 v194, 0, v194
    v_max_f32 v195, 0, v195
    v_max_f32 v196, 0, v196
    v_max_f32 v197, 0, v197
    v_max_f32 v198, 0, v198
    v_max_f32 v199, 0, v199
    v_max_f32 v200, 0, v200
    v_max_f32 v201, 0, v201
    v_pk_mul_f32 v[202:203], v[202:203], v[32:33] op_sel_hi:[1,0]
    v_pk_mul_f32 v[204:205], v[204:205], v[32:33] op_sel_hi:[1,0]
    v_pk_mul_f32 v[206:207], v[206:207], v[32:33] op_sel_hi:[1,0]
    v_pk_mul_f32 v[208:209], v[208:209], v[32:33] op_sel_hi:[1,0]
    v_pk_mul_f32 v[194:195], v[194:195], v[202:203]
    v_pk_mul_f32 v[196:197], v[196:197], v[204:205]
    v_pk_mul_f32 v[198:199], v[198:199], v[206:207]
    v_pk_mul_f32 v[200:201], v[200:201], v[208:209]
    v_cvt_pk_bf16_f32 v176, v194, v195
    v_cvt_pk_bf16_f32 v177, v196, v197
    v_cvt_pk_bf16_f32 v178, v198, v199
    v_cvt_pk_bf16_f32 v179, v200, v201
    s_waitcnt lgkmcnt(4)
    v_pk_fma_f32 v[130:131], v[50:51], v[26:27], v[130:131] op_sel_hi:[1,0,1]
    v_pk_fma_f32 v[132:133], v[52:53], v[26:27], v[132:133] op_sel_hi:[1,0,1]
    v_pk_fma_f32 v[134:135], v[54:55], v[26:27], v[134:135] op_sel_hi:[1,0,1]
    v_pk_fma_f32 v[136:137], v[56:57], v[26:27], v[136:137] op_sel_hi:[1,0,1]
    v_pk_fma_f32 v[138:139], v[58:59], v[26:27], v[138:139] op_sel_hi:[1,0,1]
    v_pk_fma_f32 v[140:141], v[60:61], v[26:27], v[140:141] op_sel_hi:[1,0,1]
    v_pk_fma_f32 v[142:143], v[62:63], v[26:27], v[142:143] op_sel_hi:[1,0,1]
    v_pk_fma_f32 v[144:145], v[64:65], v[26:27], v[144:145] op_sel_hi:[1,0,1]
    v_max_f32 v130, 0, v130
    v_max_f32 v131, 0, v131
    v_max_f32 v132, 0, v132
    v_max_f32 v133, 0, v133
    v_max_f32 v134, 0, v134
    v_max_f32 v135, 0, v135
    v_max_f32 v136, 0, v136
    v_max_f32 v137, 0, v137
    v_pk_mul_f32 v[138:139], v[138:139], v[30:31] op_sel_hi:[1,0]
    v_pk_mul_f32 v[140:141], v[140:141], v[30:31] op_sel_hi:[1,0]
    v_pk_mul_f32 v[142:143], v[142:143], v[30:31] op_sel_hi:[1,0]
    v_pk_mul_f32 v[144:145], v[144:145], v[30:31] op_sel_hi:[1,0]
    v_pk_mul_f32 v[130:131], v[130:131], v[138:139]
    v_pk_mul_f32 v[132:133], v[132:133], v[140:141]
    v_pk_mul_f32 v[134:135], v[134:135], v[142:143]
    v_pk_mul_f32 v[136:137], v[136:137], v[144:145]
    v_cvt_pk_bf16_f32 v168, v130, v131
    v_cvt_pk_bf16_f32 v169, v132, v133
    v_cvt_pk_bf16_f32 v170, v134, v135
    v_cvt_pk_bf16_f32 v171, v136, v137
    v_pk_fma_f32 v[210:211], v[50:51], v[28:29], v[210:211] op_sel_hi:[1,0,1]
    v_pk_fma_f32 v[212:213], v[52:53], v[28:29], v[212:213] op_sel_hi:[1,0,1]
    v_pk_fma_f32 v[214:215], v[54:55], v[28:29], v[214:215] op_sel_hi:[1,0,1]
    v_pk_fma_f32 v[216:217], v[56:57], v[28:29], v[216:217] op_sel_hi:[1,0,1]
    v_pk_fma_f32 v[218:219], v[58:59], v[28:29], v[218:219] op_sel_hi:[1,0,1]
    v_pk_fma_f32 v[220:221], v[60:61], v[28:29], v[220:221] op_sel_hi:[1,0,1]
    v_pk_fma_f32 v[222:223], v[62:63], v[28:29], v[222:223] op_sel_hi:[1,0,1]
    v_pk_fma_f32 v[224:225], v[64:65], v[28:29], v[224:225] op_sel_hi:[1,0,1]
    v_max_f32 v210, 0, v210
    v_max_f32 v211, 0, v211
    v_max_f32 v212, 0, v212
    v_max_f32 v213, 0, v213
    v_max_f32 v214, 0, v214
    v_max_f32 v215, 0, v215
    v_max_f32 v216, 0, v216
    v_max_f32 v217, 0, v217
    v_pk_mul_f32 v[218:219], v[218:219], v[32:33] op_sel_hi:[1,0]
    v_pk_mul_f32 v[220:221], v[220:221], v[32:33] op_sel_hi:[1,0]
    v_pk_mul_f32 v[222:223], v[222:223], v[32:33] op_sel_hi:[1,0]
    v_pk_mul_f32 v[224:225], v[224:225], v[32:33] op_sel_hi:[1,0]
    v_pk_mul_f32 v[210:211], v[210:211], v[218:219]
    v_pk_mul_f32 v[212:213], v[212:213], v[220:221]
    v_pk_mul_f32 v[214:215], v[214:215], v[222:223]
    v_pk_mul_f32 v[216:217], v[216:217], v[224:225]
    v_cvt_pk_bf16_f32 v180, v210, v211
    v_cvt_pk_bf16_f32 v181, v212, v213
    v_cvt_pk_bf16_f32 v182, v214, v215
    v_cvt_pk_bf16_f32 v183, v216, v217
    s_waitcnt lgkmcnt(0)
    v_pk_fma_f32 v[146:147], v[66:67], v[26:27], v[146:147] op_sel_hi:[1,0,1]
    v_pk_fma_f32 v[148:149], v[68:69], v[26:27], v[148:149] op_sel_hi:[1,0,1]
    v_pk_fma_f32 v[150:151], v[70:71], v[26:27], v[150:151] op_sel_hi:[1,0,1]
    v_pk_fma_f32 v[152:153], v[72:73], v[26:27], v[152:153] op_sel_hi:[1,0,1]
    v_pk_fma_f32 v[154:155], v[74:75], v[26:27], v[154:155] op_sel_hi:[1,0,1]
    v_pk_fma_f32 v[156:157], v[76:77], v[26:27], v[156:157] op_sel_hi:[1,0,1]
    v_pk_fma_f32 v[158:159], v[78:79], v[26:27], v[158:159] op_sel_hi:[1,0,1]
    v_pk_fma_f32 v[160:161], v[80:81], v[26:27], v[160:161] op_sel_hi:[1,0,1]
    v_max_f32 v146, 0, v146
    v_max_f32 v147, 0, v147
    v_max_f32 v148, 0, v148
    v_max_f32 v149, 0, v149
    v_max_f32 v150, 0, v150
    v_max_f32 v151, 0, v151
    v_max_f32 v152, 0, v152
    v_max_f32 v153, 0, v153
    v_pk_mul_f32 v[154:155], v[154:155], v[30:31] op_sel_hi:[1,0]
    v_pk_mul_f32 v[156:157], v[156:157], v[30:31] op_sel_hi:[1,0]
    v_pk_mul_f32 v[158:159], v[158:159], v[30:31] op_sel_hi:[1,0]
    v_pk_mul_f32 v[160:161], v[160:161], v[30:31] op_sel_hi:[1,0]
    v_pk_mul_f32 v[146:147], v[146:147], v[154:155]
    v_pk_mul_f32 v[148:149], v[148:149], v[156:157]
    v_pk_mul_f32 v[150:151], v[150:151], v[158:159]
    v_pk_mul_f32 v[152:153], v[152:153], v[160:161]
    v_cvt_pk_bf16_f32 v172, v146, v147
    v_cvt_pk_bf16_f32 v173, v148, v149
    v_cvt_pk_bf16_f32 v174, v150, v151
    v_cvt_pk_bf16_f32 v175, v152, v153
    v_pk_fma_f32 v[226:227], v[66:67], v[28:29], v[226:227] op_sel_hi:[1,0,1]
    v_pk_fma_f32 v[228:229], v[68:69], v[28:29], v[228:229] op_sel_hi:[1,0,1]
    v_pk_fma_f32 v[230:231], v[70:71], v[28:29], v[230:231] op_sel_hi:[1,0,1]
    v_pk_fma_f32 v[232:233], v[72:73], v[28:29], v[232:233] op_sel_hi:[1,0,1]
    v_pk_fma_f32 v[234:235], v[74:75], v[28:29], v[234:235] op_sel_hi:[1,0,1]
    v_pk_fma_f32 v[236:237], v[76:77], v[28:29], v[236:237] op_sel_hi:[1,0,1]
    v_pk_fma_f32 v[238:239], v[78:79], v[28:29], v[238:239] op_sel_hi:[1,0,1]
    v_pk_fma_f32 v[240:241], v[80:81], v[28:29], v[240:241] op_sel_hi:[1,0,1]
    v_max_f32 v226, 0, v226
    v_max_f32 v227, 0, v227
    v_max_f32 v228, 0, v228
    v_max_f32 v229, 0, v229
    v_max_f32 v230, 0, v230
    v_max_f32 v231, 0, v231
    v_max_f32 v232, 0, v232
    v_max_f32 v233, 0, v233
    v_pk_mul_f32 v[234:235], v[234:235], v[32:33] op_sel_hi:[1,0]
    v_pk_mul_f32 v[236:237], v[236:237], v[32:33] op_sel_hi:[1,0]
    v_pk_mul_f32 v[238:239], v[238:239], v[32:33] op_sel_hi:[1,0]
    v_pk_mul_f32 v[240:241], v[240:241], v[32:33] op_sel_hi:[1,0]
    v_pk_mul_f32 v[226:227], v[226:227], v[234:235]
    v_pk_mul_f32 v[228:229], v[228:229], v[236:237]
    v_pk_mul_f32 v[230:231], v[230:231], v[238:239]
    v_pk_mul_f32 v[232:233], v[232:233], v[240:241]
    v_cvt_pk_bf16_f32 v184, v226, v227
    v_cvt_pk_bf16_f32 v185, v228, v229
    v_cvt_pk_bf16_f32 v186, v230, v231
    v_cvt_pk_bf16_f32 v187, v232, v233
    s_mul_i32 s33, s32, 6144
    v_add_u32 v2, s33, v1
    ds_write_b128 v2, v[164:167] offset:8192
    ds_write_b128 v2, v[168:171] offset:9216
    ds_write_b128 v2, v[172:175] offset:10240
    ds_write_b128 v2, v[176:179] offset:11264
    ds_write_b128 v2, v[180:183] offset:12288
    ds_write_b128 v2, v[184:187] offset:13312
    s_waitcnt vmcnt(0) lgkmcnt(0)
    s_barrier
parallel_sum__softmax_full_mha__glu_gated_reglu__prompt_kernel_att:
    s_setprio 3
    s_load_dwordx2 s[8:9], s[0:1], 72
    s_and_b32 s6, s2, 7
    s_lshr_b32 s7, s2, 3
    s_lshr_b32 s12, s7, 3
    s_lshl_b32 s6, s6, 2
    s_add_u32 s12, s12, s6
    s_and_b32 s7, s7, 7
    s_lshl_b32 s13, s7, 3
    s_lshl_b32 s6, s3, 1
    s_add_u32 s13, s13, s6
    v_lshlrev_b32 v1, 4, v0
    v_and_b32 v5, 31, v0
    v_lshlrev_b32 v2, 3, v5
    s_mul_i32 s17, s12, 172032
    s_add_u32 s17, s17, 2621440
    s_lshl_b32 s26, s12, 6
    s_add_u32 s26, s26, s13
    s_mul_i32 s26, s26, 1280
    s_mul_i32 s20, s12, 1280
    s_add_u32 s20, s20, 8142848
    v_lshlrev_b32 v6, 2, v0
    s_mov_b32 s10, 20512768
    s_mov_b32 s11, 0x20000
    v_lshlrev_b32 v7, 4, v5
    s_waitcnt lgkmcnt(0)
    buffer_load_dwordx4 v[8:11], v1, s[8:11], s26 offen offset:0
    buffer_load_dwordx2 v[12:13], v2, s[8:11], s26 offen offset:1024
    buffer_load_dwordx4 v[16:19], v1, s[8:11], s26 offen offset:1280
    buffer_load_dwordx2 v[20:21], v2, s[8:11], s26 offen offset:2304
    buffer_load_dword v40, v6, s[8:11], s20 offen offset:0
    buffer_load_dword v41, v6, s[8:11], s20 offen offset:256
    buffer_load_dword v42, v6, s[8:11], s20 offen offset:512
    buffer_load_dword v43, v6, s[8:11], s20 offen offset:768
    buffer_load_dword v44, v6, s[8:11], s20 offen offset:1024
    v_lshrrev_b32 v6, 5, v0
    v_mul_u32_u24 v6, 320, v6
    v_add_u32 v3, v7, v6
    v_and_b32 v6, 27, v0
    v_cmp_eq_u32 vcc, 24, v6
    v_mov_b32 v6, 1296
    v_mov_b32 v4, 1280
    v_cndmask_b32 v6, v6, v4, vcc
    v_cmp_gt_u32 vcc, 20, v5
    v_subrev_u32 v4, 640, v6
    s_nop 0
    v_cndmask_b32 v4, v4, v3, vcc
    v_cndmask_b32 v3, v6, v3, vcc
    s_mov_b32 s24, -1
    s_mov_b32 s25, 0
    s_mov_b32 s19, 0
    v_add_u32 v22, 1024, v2
    v_mov_b32 v6, 2560
    v_cndmask_b32 v22, v6, v22, s[24:25]
    v_subrev_u32 v22, 0, v22
parallel_sum__softmax_full_mha__glu_gated_reglu__prompt_kernel_a_restart:
    s_add_u32 s28, s8, s17
    s_addc_u32 s29, s9, 0
    global_load_dwordx4 v[104:107], v1, s[28:29] offset:0
    global_load_dwordx2 v[116:117], v22, s[28:29] offset:0
    global_load_dwordx4 v[108:111], v3, s[28:29] offset:1280
    global_load_dwordx4 v[112:115], v4, s[28:29] offset:1920
    global_load_dwordx4 v[118:121], v1, s[28:29] offset:2688
    global_load_dwordx2 v[130:131], v22, s[28:29] offset:2688
    s_add_u32 s28, s28, 2688
    s_addc_u32 s29, s29, 0
    global_load_dwordx4 v[122:125], v3, s[28:29] offset:1280
    global_load_dwordx4 v[126:129], v4, s[28:29] offset:1920
    global_load_dwordx4 v[132:135], v1, s[28:29] offset:2688
    global_load_dwordx2 v[144:145], v22, s[28:29] offset:2688
    s_add_u32 s28, s28, 2688
    s_addc_u32 s29, s29, 0
    global_load_dwordx4 v[136:139], v3, s[28:29] offset:1280
    global_load_dwordx4 v[140:143], v4, s[28:29] offset:1920
    global_load_dwordx4 v[146:149], v1, s[28:29] offset:2688
    global_load_dwordx2 v[158:159], v22, s[28:29] offset:2688
    s_add_u32 s28, s28, 2688
    s_addc_u32 s29, s29, 0
    v_mov_b32 v72, 0
    v_mov_b32 v73, 0
    v_mov_b32 v74, 0
    v_mov_b32 v75, 0
    v_mov_b32 v76, 0
    v_mov_b32 v77, 0
    v_mov_b32 v78, 0
    v_mov_b32 v79, 0
    v_mov_b32 v80, 0
    v_mov_b32 v81, 0
    v_mov_b32 v82, 0
    v_mov_b32 v83, 0
    v_mov_b32 v84, 0
    v_mov_b32 v85, 0
    v_mov_b32 v86, 0
    v_mov_b32 v87, 0
    v_mov_b32 v88, 0
    v_mov_b32 v89, 0
    v_mov_b32 v90, 0
    v_mov_b32 v91, 0
    v_mov_b32 v92, 0
    v_mov_b32 v93, 0
    v_mov_b32 v94, 0
    v_mov_b32 v95, 0
    v_mov_b32 v96, 0
    v_mov_b32 v97, 0
    v_mov_b32 v98, 0
    v_mov_b32 v99, 0
    v_mov_b32 v100, 0
    v_mov_b32 v101, 0
    v_mov_b32 v102, 0
    v_mov_b32 v103, 0
    s_mov_b32 s16, 16
    s_cmp_lg_u32 s19, 0
    s_cbranch_scc1 parallel_sum__softmax_full_mha__glu_gated_reglu__prompt_kernel_a_haveq
    s_waitcnt vmcnt(14)
    v_add_f32 v40, v40, v41
    v_add_f32 v42, v42, v43
    v_add_f32 v40, v40, v44
    v_add_f32 v40, v40, v42
    v_mov_b32 v24, 0
    v_mov_b32 v28, 0
    v_mov_b32 v26, 0
    v_mov_b32 v29, 0
    v_max_f32_dpp v40, v40, v40 quad_perm:[1,0,3,2] row_mask:0xf bank_mask:0xf
    v_dot2c_f32_bf16 v24, v8, v8
    v_dot2c_f32_bf16 v26, v16, v16
    v_max_f32_dpp v40, v40, v40 quad_perm:[2,3,0,1] row_mask:0xf bank_mask:0xf
    v_dot2c_f32_bf16 v24, v9, v9
    v_dot2c_f32_bf16 v26, v17, v17
    v_max_f32_dpp v40, v40, v40 row_half_mirror row_mask:0xf bank_mask:0xf
    v_dot2c_f32_bf16 v24, v10, v10
    v_dot2c_f32_bf16 v26, v18, v18
    v_max_f32_dpp v40, v40, v40 row_mirror row_mask:0xf bank_mask:0xf
    v_dot2c_f32_bf16 v24, v11, v11
    v_dot2c_f32_bf16 v26, v19, v19
    v_dot2c_f32_bf16 v28, v12, v12
    v_dot2c_f32_bf16 v29, v20, v20
    v_dot2c_f32_bf16 v28, v13, v13
    v_dot2c_f32_bf16 v29, v21, v21
    v_readlane_b32 s18, v40, 0
    v_readlane_b32 s6, v40, 16
    v_readlane_b32 s7, v40, 32
    v_readlane_b32 s20, v40, 48
    v_mov_b32 v25, v24
    v_mov_b32 v27, v26
    s_max_u32 s18, s18, s6
    s_max_u32 s7, s7, s20
    s_max_u32 s18, s18, s7
    v_permlane32_swap_b32 v25, v24
    v_permlane32_swap_b32 v27, v26
    v_add_f32 v24, v24, v25
    v_add_f32 v26, v26, v27
    v_add_f32 v24, v24, v28
    v_add_f32 v26, v26, v29
    v_mul_f32 v24, s18, v24
    v_mul_f32 v26, s18, v26
    v_sqrt_f32 v24, v24
    v_sqrt_f32 v26, v26
    v_cndmask_b32 v13, 0, v13, s[24:25]
    v_cndmask_b32 v21, 0, v21, s[24:25]
    v_mul_f32 v24, 0xbf810000, v24
    v_mul_f32 v26, 0xbf810000, v26
    v_cvt_pk_bf16_f32 v24, v24, 0
    v_cvt_pk_bf16_f32 v26, v26, 0
    v_cndmask_b32 v12, v24, v12, s[24:25]
    v_cndmask_b32 v20, v26, v20, s[24:25]
parallel_sum__softmax_full_mha__glu_gated_reglu__prompt_kernel_a_haveq:
    s_waitcnt vmcnt(12)
    v_mfma_f32_32x32x16_bf16 v[24:39], v[104:107], v[8:11], 0
    v_mfma_f32_32x32x8bf16_1k v[24:39], v[116:117], v[12:13], v[24:39]
    s_nop 9
    s_nop 1
    v_exp_f32 v24, v24
    v_exp_f32 v25, v25
.p2align 3
parallel_sum__softmax_full_mha__glu_gated_reglu__prompt_kernel_a_loop:
    global_load_dwordx4 v[150:153], v3, s[28:29] offset:1280
    v_exp_f32 v26, v26
    v_exp_f32 v27, v27
    v_exp_f32 v28, v28
    v_exp_f32 v29, v29
    v_mfma_f32_32x32x16_bf16 v[40:55], v[104:107], v[16:19], 0
    global_load_dwordx4 v[154:157], v4, s[28:29] offset:1920
    v_exp_f32 v30, v30
    v_exp_f32 v31, v31
    v_cvt_pk_bf16_f32 v56, v24, v25
    v_cvt_pk_bf16_f32 v57, v26, v27
    v_cvt_pk_bf16_f32 v58, v28, v29
    v_cvt_pk_bf16_f32 v59, v30, v31
    v_mfma_f32_32x32x8bf16_1k v[40:55], v[116:117], v[20:21], v[40:55]
    s_waitcnt vmcnt(10)
    v_exp_f32 v32, v32
    v_exp_f32 v33, v33
    v_exp_f32 v34, v34
    v_exp_f32 v35, v35
    v_mfma_f32_32x32x16_bf16 v[72:87], v[108:111], v[56:59], v[72:87]
    v_exp_f32 v36, v36
    v_exp_f32 v37, v37
    v_exp_f32 v38, v38
    v_exp_f32 v39, v39
    v_cvt_pk_bf16_f32 v60, v32, v33
    v_cvt_pk_bf16_f32 v61, v34, v35
    v_cvt_pk_bf16_f32 v62, v36, v37
    v_cvt_pk_bf16_f32 v63, v38, v39
    v_exp_f32 v40, v40
    v_exp_f32 v41, v41
    v_mfma_f32_32x32x16_bf16 v[72:87], v[112:115], v[60:63], v[72:87]
    global_load_dwordx4 v[104:107], v1, s[28:29] offset:2688
    v_exp_f32 v42, v42
    v_exp_f32 v43, v43
    v_exp_f32 v44, v44
    v_exp_f32 v45, v45
    v_mfma_f32_32x32x16_bf16 v[24:39], v[118:121], v[8:11], 0
    global_load_dwordx2 v[116:117], v22, s[28:29] offset:2688
    v_exp_f32 v46, v46
    v_exp_f32 v47, v47
    v_cvt_pk_bf16_f32 v64, v40, v41
    v_cvt_pk_bf16_f32 v65, v42, v43
    v_cvt_pk_bf16_f32 v66, v44, v45
    v_cvt_pk_bf16_f32 v67, v46, v47
    v_mfma_f32_32x32x8bf16_1k v[24:39], v[130:131], v[12:13], v[24:39]
    v_exp_f32 v48, v48
    v_exp_f32 v49, v49
    v_exp_f32 v50, v50
    v_exp_f32 v51, v51
    v_mfma_f32_32x32x16_bf16 v[88:103], v[108:111], v[64:67], v[88:103]
    s_add_u32 s28, s28, 2688
    s_addc_u32 s29, s29, 0
    v_exp_f32 v52, v52
    v_exp_f32 v53, v53
    v_exp_f32 v54, v54
    v_exp_f32 v55, v55
    v_cvt_pk_bf16_f32 v68, v48, v49
    v_cvt_pk_bf16_f32 v69, v50, v51
    v_cvt_pk_bf16_f32 v70, v52, v53
    v_cvt_pk_bf16_f32 v71, v54, v55
    v_exp_f32 v24, v24
    v_exp_f32 v25, v25
    v_mfma_f32_32x32x16_bf16 v[88:103], v[112:115], v[68:71], v[88:103]
    global_load_dwordx4 v[108:111], v3, s[28:29] offset:1280
    v_exp_f32 v26, v26
    v_exp_f32 v27, v27
    v_exp_f32 v28, v28
    v_exp_f32 v29, v29
    v_mfma_f32_32x32x16_bf16 v[40:55], v[118:121], v[16:19], 0
    global_load_dwordx4 v[112:115], v4, s[28:29] offset:1920
    v_exp_f32 v30, v30
    v_exp_f32 v31, v31
    v_cvt_pk_bf16_f32 v56, v24, v25
    v_cvt_pk_bf16_f32 v57, v26, v27
    v_cvt_pk_bf16_f32 v58, v28, v29
    v_cvt_pk_bf16_f32 v59, v30, v31
    v_mfma_f32_32x32x8bf16_1k v[40:55], v[130:131], v[20:21], v[40:55]
    s_waitcnt vmcnt(10)
    v_exp_f32 v32, v32
    v_exp_f32 v33, v33
    v_exp_f32 v34, v34
    v_exp_f32 v35, v35
    v_mfma_f32_32x32x16_bf16 v[72:87], v[122:125], v[56:59], v[72:87]
    v_exp_f32 v36, v36
    v_exp_f32 v37, v37
    v_exp_f32 v38, v38
    v_exp_f32 v39, v39
    v_cvt_pk_bf16_f32 v60, v32, v33
    v_cvt_pk_bf16_f32 v61, v34, v35
    v_cvt_pk_bf16_f32 v62, v36, v37
    v_cvt_pk_bf16_f32 v63, v38, v39
    v_exp_f32 v40, v40
    v_exp_f32 v41, v41
    v_mfma_f32_32x32x16_bf16 v[72:87], v[126:129], v[60:63], v[72:87]
    global_load_dwordx4 v[118:121], v1, s[28:29] offset:2688
    v_exp_f32 v42, v42
    v_exp_f32 v43, v43
    v_exp_f32 v44, v44
    v_exp_f32 v45, v45
    v_mfma_f32_32x32x16_bf16 v[24:39], v[132:135], v[8:11], 0
    global_load_dwordx2 v[130:131], v22, s[28:29] offset:2688
    v_exp_f32 v46, v46
    v_exp_f32 v47, v47
    v_cvt_pk_bf16_f32 v64, v40, v41
    v_cvt_pk_bf16_f32 v65, v42, v43
    v_cvt_pk_bf16_f32 v66, v44, v45
    v_cvt_pk_bf16_f32 v67, v46, v47
    v_mfma_f32_32x32x8bf16_1k v[24:39], v[144:145], v[12:13], v[24:39]
    v_exp_f32 v48, v48
    v_exp_f32 v49, v49
    v_exp_f32 v50, v50
    v_exp_f32 v51, v51
    v_mfma_f32_32x32x16_bf16 v[88:103], v[122:125], v[64:67], v[88:103]
    s_add_u32 s28, s28, 2688
    s_addc_u32 s29, s29, 0
    v_exp_f32 v52, v52
    v_exp_f32 v53, v53
    v_exp_f32 v54, v54
    v_exp_f32 v55, v55
    v_cvt_pk_bf16_f32 v68, v48, v49
    v_cvt_pk_bf16_f32 v69, v50, v51
    v_cvt_pk_bf16_f32 v70, v52, v53
    v_cvt_pk_bf16_f32 v71, v54, v55
    v_exp_f32 v24, v24
    v_exp_f32 v25, v25
    v_mfma_f32_32x32x16_bf16 v[88:103], v[126:129], v[68:71], v[88:103]
    global_load_dwordx4 v[122:125], v3, s[28:29] offset:1280
    v_exp_f32 v26, v26
    v_exp_f32 v27, v27
    v_exp_f32 v28, v28
    v_exp_f32 v29, v29
    v_mfma_f32_32x32x16_bf16 v[40:55], v[132:135], v[16:19], 0
    global_load_dwordx4 v[126:129], v4, s[28:29] offset:1920
    v_exp_f32 v30, v30
    v_exp_f32 v31, v31
    v_cvt_pk_bf16_f32 v56, v24, v25
    v_cvt_pk_bf16_f32 v57, v26, v27
    v_cvt_pk_bf16_f32 v58, v28, v29
    v_cvt_pk_bf16_f32 v59, v30, v31
    v_mfma_f32_32x32x8bf16_1k v[40:55], v[144:145], v[20:21], v[40:55]
    s_waitcnt vmcnt(10)
    v_exp_f32 v32, v32
    v_exp_f32 v33, v33
    v_exp_f32 v34, v34
    v_exp_f32 v35, v35
    v_mfma_f32_32x32x16_bf16 v[72:87], v[136:139], v[56:59], v[72:87]
    v_exp_f32 v36, v36
    v_exp_f32 v37, v37
    v_exp_f32 v38, v38
    v_exp_f32 v39, v39
    v_cvt_pk_bf16_f32 v60, v32, v33
    v_cvt_pk_bf16_f32 v61, v34, v35
    v_cvt_pk_bf16_f32 v62, v36, v37
    v_cvt_pk_bf16_f32 v63, v38, v39
    v_exp_f32 v40, v40
    v_exp_f32 v41, v41
    v_mfma_f32_32x32x16_bf16 v[72:87], v[140:143], v[60:63], v[72:87]
    global_load_dwordx4 v[132:135], v1, s[28:29] offset:2688
    v_exp_f32 v42, v42
    v_exp_f32 v43, v43
    v_exp_f32 v44, v44
    v_exp_f32 v45, v45
    v_mfma_f32_32x32x16_bf16 v[24:39], v[146:149], v[8:11], 0
    global_load_dwordx2 v[144:145], v22, s[28:29] offset:2688
    v_exp_f32 v46, v46
    v_exp_f32 v47, v47
    v_cvt_pk_bf16_f32 v64, v40, v41
    v_cvt_pk_bf16_f32 v65, v42, v43
    v_cvt_pk_bf16_f32 v66, v44, v45
    v_cvt_pk_bf16_f32 v67, v46, v47
    v_mfma_f32_32x32x8bf16_1k v[24:39], v[158:159], v[12:13], v[24:39]
    v_exp_f32 v48, v48
    v_exp_f32 v49, v49
    v_exp_f32 v50, v50
    v_exp_f32 v51, v51
    v_mfma_f32_32x32x16_bf16 v[88:103], v[136:139], v[64:67], v[88:103]
    s_add_u32 s28, s28, 2688
    s_addc_u32 s29, s29, 0
    v_exp_f32 v52, v52
    v_exp_f32 v53, v53
    v_exp_f32 v54, v54
    v_exp_f32 v55, v55
    v_cvt_pk_bf16_f32 v68, v48, v49
    v_cvt_pk_bf16_f32 v69, v50, v51
    v_cvt_pk_bf16_f32 v70, v52, v53
    v_cvt_pk_bf16_f32 v71, v54, v55
    v_exp_f32 v24, v24
    v_exp_f32 v25, v25
    v_mfma_f32_32x32x16_bf16 v[88:103], v[140:143], v[68:71], v[88:103]
    global_load_dwordx4 v[136:139], v3, s[28:29] offset:1280
    v_exp_f32 v26, v26
    v_exp_f32 v27, v27
    v_exp_f32 v28, v28
    v_exp_f32 v29, v29
    v_mfma_f32_32x32x16_bf16 v[40:55], v[146:149], v[16:19], 0
    global_load_dwordx4 v[140:143], v4, s[28:29] offset:1920
    v_exp_f32 v30, v30
    v_exp_f32 v31, v31
    v_cvt_pk_bf16_f32 v56, v24, v25
    v_cvt_pk_bf16_f32 v57, v26, v27
    v_cvt_pk_bf16_f32 v58, v28, v29
    v_cvt_pk_bf16_f32 v59, v30, v31
    v_mfma_f32_32x32x8bf16_1k v[40:55], v[158:159], v[20:21], v[40:55]
    s_waitcnt vmcnt(10)
    v_exp_f32 v32, v32
    v_exp_f32 v33, v33
    v_exp_f32 v34, v34
    v_exp_f32 v35, v35
    v_mfma_f32_32x32x16_bf16 v[72:87], v[150:153], v[56:59], v[72:87]
    s_sub_u32 s16, s16, 1
    v_exp_f32 v36, v36
    v_exp_f32 v37, v37
    v_exp_f32 v38, v38
    v_exp_f32 v39, v39
    v_cvt_pk_bf16_f32 v60, v32, v33
    v_cvt_pk_bf16_f32 v61, v34, v35
    v_cvt_pk_bf16_f32 v62, v36, v37
    v_cvt_pk_bf16_f32 v63, v38, v39
    v_exp_f32 v40, v40
    v_exp_f32 v41, v41
    v_mfma_f32_32x32x16_bf16 v[72:87], v[154:157], v[60:63], v[72:87]
    global_load_dwordx4 v[146:149], v1, s[28:29] offset:2688
    v_exp_f32 v42, v42
    v_exp_f32 v43, v43
    v_exp_f32 v44, v44
    v_exp_f32 v45, v45
    v_mfma_f32_32x32x16_bf16 v[24:39], v[104:107], v[8:11], 0
    global_load_dwordx2 v[158:159], v22, s[28:29] offset:2688
    v_exp_f32 v46, v46
    v_exp_f32 v47, v47
    v_cvt_pk_bf16_f32 v64, v40, v41
    v_cvt_pk_bf16_f32 v65, v42, v43
    v_cvt_pk_bf16_f32 v66, v44, v45
    v_cvt_pk_bf16_f32 v67, v46, v47
    v_mfma_f32_32x32x8bf16_1k v[24:39], v[116:117], v[12:13], v[24:39]
    v_exp_f32 v48, v48
    v_exp_f32 v49, v49
    v_exp_f32 v50, v50
    v_exp_f32 v51, v51
    v_mfma_f32_32x32x16_bf16 v[88:103], v[150:153], v[64:67], v[88:103]
    s_add_u32 s28, s28, 2688
    s_addc_u32 s29, s29, 0
    s_cmp_lg_u32 s16, 0
    v_exp_f32 v52, v52
    v_exp_f32 v53, v53
    v_exp_f32 v54, v54
    v_exp_f32 v55, v55
    v_cvt_pk_bf16_f32 v68, v48, v49
    v_cvt_pk_bf16_f32 v69, v50, v51
    v_cvt_pk_bf16_f32 v70, v52, v53
    v_cvt_pk_bf16_f32 v71, v54, v55
    v_exp_f32 v24, v24
    v_exp_f32 v25, v25
    v_mfma_f32_32x32x16_bf16 v[88:103], v[154:157], v[68:71], v[88:103]
    s_cbranch_scc1 parallel_sum__softmax_full_mha__glu_gated_reglu__prompt_kernel_a_loop
    s_cmp_lg_u32 s19, 0
    s_cbranch_scc1 parallel_sum__softmax_full_mha__glu_gated_reglu__prompt_kernel_a_store
    v_mov_b32 v5, 0x21800000
    v_cmp_ge_f32 vcc, v84, v5
    s_nop 6
    v_cmp_ge_f32 s[6:7], v100, v5
    s_nop 1
    s_and_b64 s[6:7], s[6:7], vcc
    s_cmp_eq_u64 s[6:7], -1
    s_cbranch_scc1 parallel_sum__softmax_full_mha__glu_gated_reglu__prompt_kernel_a_store
    s_waitcnt vmcnt(0)
    v_cndmask_b32 v12, 0, v12, s[24:25]
    v_cndmask_b32 v13, 0, v13, s[24:25]
    v_mov_b32 v160, 0xff800000
    v_cndmask_b32 v20, 0, v20, s[24:25]
    v_cndmask_b32 v21, 0, v21, s[24:25]
    v_mov_b32 v161, 0xff800000
    s_add_u32 s28, s8, s17
    s_addc_u32 s29, s9, 0
    s_mov_b32 s16, 64
parallel_sum__softmax_full_mha__glu_gated_reglu__prompt_kernel_a_maxloop:
    global_load_dwordx4 v[104:107], v1, s[28:29] offset:0
    global_load_dwordx2 v[116:117], v22, s[28:29] offset:0
    s_add_u32 s28, s28, 2688
    s_addc_u32 s29, s29, 0
    s_waitcnt vmcnt(0)
    v_mfma_f32_32x32x16_bf16 v[24:39], v[104:107], v[8:11], 0
    v_mfma_f32_32x32x8bf16_1k v[24:39], v[116:117], v[12:13], v[24:39]
    v_mfma_f32_32x32x16_bf16 v[40:55], v[104:107], v[16:19], 0
    v_mfma_f32_32x32x8bf16_1k v[40:55], v[116:117], v[20:21], v[40:55]
    s_nop 9
    v_max3_f32 v160, v24, v25, v160
    v_max3_f32 v160, v26, v27, v160
    v_max3_f32 v160, v28, v29, v160
    v_max3_f32 v160, v30, v31, v160
    v_max3_f32 v160, v32, v33, v160
    v_max3_f32 v160, v34, v35, v160
    v_max3_f32 v160, v36, v37, v160
    v_max3_f32 v160, v38, v39, v160
    v_max3_f32 v161, v40, v41, v161
    v_max3_f32 v161, v42, v43, v161
    v_max3_f32 v161, v44, v45, v161
    v_max3_f32 v161, v46, v47, v161
    v_max3_f32 v161, v48, v49, v161
    v_max3_f32 v161, v50, v51, v161
    v_max3_f32 v161, v52, v53, v161
    v_max3_f32 v161, v54, v55, v161
    s_sub_u32 s16, s16, 1
    s_cmp_lg_u32 s16, 0
    s_cbranch_scc1 parallel_sum__softmax_full_mha__glu_gated_reglu__prompt_kernel_a_maxloop
    v_mov_b32 v24, v160
    s_nop 1
    v_permlane32_swap_b32 v24, v160
    v_max_f32 v160, v160, v24
    v_sub_f32 v160, 0, v160
    v_and_b32 v24, 0xffff0000, v160
    v_sub_f32 v160, v160, v24
    v_and_b32 v25, 0xffff0000, v160
    v_sub_f32 v160, v160, v25
    v_lshrrev_b32 v24, 16, v24
    v_or_b32 v24, v24, v25
    v_lshrrev_b32 v26, 16, v160
    v_cndmask_b32 v12, v24, v12, s[24:25]
    v_cndmask_b32 v13, v26, v13, s[24:25]
    v_mov_b32 v24, v161
    s_nop 1
    v_permlane32_swap_b32 v24, v161
    v_max_f32 v161, v161, v24
    v_sub_f32 v161, 0, v161
    v_and_b32 v24, 0xffff0000, v161
    v_sub_f32 v161, v161, v24
    v_and_b32 v25, 0xffff0000, v161
    v_sub_f32 v161, v161, v25
    v_lshrrev_b32 v24, 16, v24
    v_or_b32 v24, v24, v25
    v_lshrrev_b32 v26, 16, v161
    v_cndmask_b32 v20, v24, v20, s[24:25]
    v_cndmask_b32 v21, v26, v21, s[24:25]
    s_mov_b32 s19, 1
    s_branch parallel_sum__softmax_full_mha__glu_gated_reglu__prompt_kernel_a_restart
parallel_sum__softmax_full_mha__glu_gated_reglu__prompt_kernel_a_store:
    v_rcp_f32 v40, v84
    s_nop 7
    v_rcp_f32 v41, v100
    s_lshr_b32 s6, s12, 2
    s_mul_i32 s6, s6, 5
    s_and_b32 s7, s12, 3
    s_add_u32 s20, s6, s7
    s_lshl_b32 s20, s20, 10
    s_add_u32 s6, s6, 4
    s_lshl_b32 s6, s6, 10
    s_lshr_b32 s16, s7, 1
    s_lshl_b32 s16, s16, 9
    s_add_u32 s6, s6, s16
    s_and_b32 s7, s7, 1
    s_lshl_b32 s7, s7, 3
    s_add_u32 s6, s6, s7
    s_mul_i32 s7, s13, 139264
    s_add_u32 s7, s7, 8208384
    s_add_u32 s20, s20, s7
    s_add_u32 s6, s6, s7
    s_add_u32 s18, s20, 139264
    s_add_u32 s7, s6, 139264
    v_mul_f32 v72, v72, v40
    v_mul_f32 v73, v73, v40
    v_mul_f32 v74, v74, v40
    v_mul_f32 v75, v75, v40
    v_mul_f32 v76, v76, v40
    v_mul_f32 v77, v77, v40
    v_mul_f32 v78, v78, v40
    v_mul_f32 v79, v79, v40
    v_mul_f32 v80, v80, v40
    v_mul_f32 v81, v81, v40
    v_mul_f32 v82, v82, v40
    v_mul_f32 v83, v83, v40
    v_cvt_pk_bf16_f32 v56, v72, v73
    v_cvt_pk_bf16_f32 v57, v74, v75
    v_cvt_pk_bf16_f32 v58, v76, v77
    v_cvt_pk_bf16_f32 v59, v78, v79
    v_cvt_pk_bf16_f32 v60, v80, v81
    v_cvt_pk_bf16_f32 v61, v82, v83
    buffer_store_dwordx4 v[56:59], v1, s[8:11], s20 offen sc1
    v_mul_f32 v88, v88, v41
    v_mul_f32 v89, v89, v41
    v_mul_f32 v90, v90, v41
    v_mul_f32 v91, v91, v41
    v_mul_f32 v92, v92, v41
    v_mul_f32 v93, v93, v41
    v_mul_f32 v94, v94, v41
    v_mul_f32 v95, v95, v41
    v_mul_f32 v96, v96, v41
    v_mul_f32 v97, v97, v41
    v_mul_f32 v98, v98, v41
    v_mul_f32 v99, v99, v41
    v_cvt_pk_bf16_f32 v64, v88, v89
    v_cvt_pk_bf16_f32 v65, v90, v91
    v_cvt_pk_bf16_f32 v66, v92, v93
    v_cvt_pk_bf16_f32 v67, v94, v95
    v_cvt_pk_bf16_f32 v68, v96, v97
    v_cvt_pk_bf16_f32 v69, v98, v99
    buffer_store_dwordx4 v[64:67], v1, s[8:11], s18 offen sc1
    s_mov_b64 exec, s[24:25]
    buffer_store_dwordx2 v[60:61], v7, s[8:11], s6 offen sc1
    buffer_store_dwordx2 v[68:69], v7, s[8:11], s7 offen sc1
    s_mov_b64 exec, -1
    v_mov_b32 v240, 139392
parallel_sum__softmax_full_mha__glu_gated_reglu__prompt_kernel_f3:
    ds_read_b32 v241, v240 offset:8
    s_waitcnt lgkmcnt(0)
    v_readfirstlane_b32 s4, v241
    s_nop 1
    s_cmp_lt_u32 s4, 4
    s_cbranch_scc1 parallel_sum__softmax_full_mha__glu_gated_reglu__prompt_kernel_f3
    s_load_dwordx2 s[32:33], s[0:1], 64
    s_lshr_b32 s36, s13, 3
    s_load_dwordx2 s[16:17], s[0:1], 0
    s_load_dwordx2 s[20:21], s[0:1], 56
    s_and_b32 s6, s2, 7
    s_lshr_b32 s7, s2, 3
    s_lshr_b32 s25, s7, 3
    s_and_b32 s4, s6, 1
    s_lshl_b32 s4, s4, 2
    s_add_u32 s25, s25, s4
    s_lshl_b32 s4, s3, 6
    v_add_u32 v7, s4, v0
    v_lshlrev_b32 v1, 4, v0
    v_add_u32 v2, 139264, v1
    v_add_u32 v3, 278528, v1
    s_lshr_b32 s24, s6, 1
    s_lshl_b32 s24, s24, 3
    s_and_b32 s7, s7, 7
    s_add_u32 s24, s24, s7
    s_lshl_b32 s29, s3, 10
    s_add_u32 s29, s29, 65536
    s_mul_i32 s26, s24, 278528
    s_add_u32 s26, s26, s29
    s_add_u32 s26, s26, 8208384
    s_mul_i32 s27, s25, 417792
    s_add_u32 s27, s27, s29
    s_add_u32 s27, s27, 17121280
    s_mov_b32 s10, 19906560
    s_mov_b32 s11, 0x20000
    s_mov_b32 s28, 3
    s_cmp_ge_u32 s25, 7
    s_cselect_b32 s10, 0, s10
    s_waitcnt vmcnt(4)
    buffer_load_dwordx4 v[24:27], v1, s[8:11], s26 offen sc1
    buffer_load_dwordx4 v[28:31], v2, s[8:11], s26 offen sc1
    buffer_load_dwordx4 v[32:35], v1, s[8:11], s27 offen sc1
    buffer_load_dwordx4 v[36:39], v2, s[8:11], s27 offen sc1
    buffer_load_dwordx4 v[40:43], v3, s[8:11], s27 offen sc1
    s_add_u32 s26, s26, 4096
    s_add_u32 s27, s27, 4096
    s_mov_b32 s34, 256
    s_mov_b32 s35, 0x20000
    s_lshl_b32 s38, s36, 5
    s_add_u32 s38, s38, s12
    s_lshr_b32 s36, s24, 2
    s_lshl_b32 s36, s36, 12
    s_mov_b32 s40, s8
    s_mov_b32 s41, s9
    s_mov_b32 s42, 20512768
    s_mov_b32 s43, 0x20000
    v_and_b32 v11, 31, v0
    v_lshlrev_b32 v11, 7, v11
    s_waitcnt lgkmcnt(0)
    s_cmp_lt_u32 s25, 7
    s_cbranch_scc1 parallel_sum__softmax_full_mha__glu_gated_reglu__prompt_kernel_o_go
    s_waitcnt vmcnt(0)
    s_barrier
    s_cmp_lg_u32 s3, 0
    s_cbranch_scc1 parallel_sum__softmax_full_mha__glu_gated_reglu__prompt_kernel_o_nosigx
    s_lshl_b32 s29, s38, 7
    s_add_u32 s29, s29, 20004864
    v_mov_b32 v242, s50
    v_mov_b32 v243, s51
    v_mov_b32 v6, 0
    s_mov_b64 exec, 1
    buffer_store_dwordx2 v[242:243], v6, s[40:43], s29 offen sc1
    s_mov_b64 exec, -1
parallel_sum__softmax_full_mha__glu_gated_reglu__prompt_kernel_o_nosigx:
    s_branch parallel_sum__softmax_full_mha__glu_gated_reglu__prompt_kernel_o_fin
parallel_sum__softmax_full_mha__glu_gated_reglu__prompt_kernel_o_go:
    v_lshrrev_b32 v4, 2, v7
    v_and_b32 v5, 3, v7
    v_mul_u32_u24 v6, 1280, v4
    v_mul_u32_u24 v8, 48, v5
    s_mul_i32 s29, s25, 192
    v_add_u32 v8, s29, v8
    v_mov_b32 v12, 0x40000000
    v_add_u32 v10, 32, v8
    v_cmp_gt_u32 vcc, 1280, v10
    v_add_u32 v10, v10, v6
    s_nop 0
    v_cndmask_b32 v10, v12, v10, vcc
    v_add_u32 v9, 16, v8
    v_cmp_gt_u32 vcc, 1280, v9
    v_add_u32 v9, v9, v6
    s_nop 0
    v_cndmask_b32 v9, v12, v9, vcc
    v_add_u32 v8, 0, v8
    v_cmp_gt_u32 vcc, 1280, v8
    v_add_u32 v8, v8, v6
    s_nop 0
    v_cndmask_b32 v8, v12, v8, vcc
    s_mul_i32 s4, s24, 81920
    s_mov_b32 s18, 2621440
    s_mov_b32 s19, 0x20000
    s_mov_b32 s22, 2621440
    s_mov_b32 s23, 0x20000
    buffer_load_dwordx4 v[12:15], v8, s[16:19], s4 offen
    buffer_load_dwordx4 v[16:19], v9, s[16:19], s4 offen
    buffer_load_dwordx4 v[20:23], v10, s[16:19], s4 offen
    v_mul_u32_u24 v4, 400, v4
    v_mul_u32_u24 v5, 96, v5
    v_add_u32 v7, v4, v5
    v_and_b32 v4, 31, v0
    v_mul_u32_u24 v4, 400, v4
    v_lshrrev_b32 v5, 5, v0
    v_lshl_add_u32 v4, v5, 4, v4
    s_mul_i32 s29, s3, 25600
    v_add_u32 v4, s29, v4
    v_mov_b32 v6, 0
    v_mov_b32 v84, 0
    v_mov_b32 v85, 0
    v_mov_b32 v86, 0
    v_mov_b32 v87, 0
    v_mov_b32 v88, 0
    v_mov_b32 v89, 0
    v_mov_b32 v90, 0
    v_mov_b32 v91, 0
    v_mov_b32 v92, 0
    v_mov_b32 v93, 0
    v_mov_b32 v94, 0
    v_mov_b32 v95, 0
    v_mov_b32 v96, 0
    v_mov_b32 v97, 0
    v_mov_b32 v98, 0
    v_mov_b32 v99, 0
    v_mov_b32 v100, 0
    v_mov_b32 v101, 0
    v_mov_b32 v102, 0
    v_mov_b32 v103, 0
    v_mov_b32 v104, 0
    v_mov_b32 v105, 0
    v_mov_b32 v106, 0
    v_mov_b32 v107, 0
    v_mov_b32 v108, 0
    v_mov_b32 v109, 0
    v_mov_b32 v110, 0
    v_mov_b32 v111, 0
    v_mov_b32 v112, 0
    v_mov_b32 v113, 0
    v_mov_b32 v114, 0
    v_mov_b32 v115, 0
    v_mov_b32 v116, 0
    v_mov_b32 v117, 0
    v_mov_b32 v118, 0
    v_mov_b32 v119, 0
    v_mov_b32 v120, 0
    v_mov_b32 v121, 0
    v_mov_b32 v122, 0
    v_mov_b32 v123, 0
    v_mov_b32 v124, 0
    v_mov_b32 v125, 0
    v_mov_b32 v126, 0
    v_mov_b32 v127, 0
    v_mov_b32 v128, 0
    v_mov_b32 v129, 0
    v_mov_b32 v130, 0
    v_mov_b32 v131, 0
    v_mov_b32 v132, 0
    v_mov_b32 v133, 0
    v_mov_b32 v134, 0
    v_mov_b32 v135, 0
    v_mov_b32 v136, 0
    v_mov_b32 v137, 0
    v_mov_b32 v138, 0
    v_mov_b32 v139, 0
    v_mov_b32 v140, 0
    v_mov_b32 v141, 0
    v_mov_b32 v142, 0
    v_mov_b32 v143, 0
    v_mov_b32 v144, 0
    v_mov_b32 v145, 0
    v_mov_b32 v146, 0
    v_mov_b32 v147, 0
    v_mov_b32 v148, 0
    v_mov_b32 v149, 0
    v_mov_b32 v150, 0
    v_mov_b32 v151, 0
    v_mov_b32 v152, 0
    v_mov_b32 v153, 0
    v_mov_b32 v154, 0
    v_mov_b32 v155, 0
    v_mov_b32 v156, 0
    v_mov_b32 v157, 0
    v_mov_b32 v158, 0
    v_mov_b32 v159, 0
    v_mov_b32 v160, 0
    v_mov_b32 v161, 0
    v_mov_b32 v162, 0
    v_mov_b32 v163, 0
    v_mov_b32 v164, 0
    v_mov_b32 v165, 0
    v_mov_b32 v166, 0
    v_mov_b32 v167, 0
    v_mov_b32 v168, 0
    v_mov_b32 v169, 0
    v_mov_b32 v170, 0
    v_mov_b32 v171, 0
    v_mov_b32 v172, 0
    v_mov_b32 v173, 0
    v_mov_b32 v174, 0
    v_mov_b32 v175, 0
    v_mov_b32 v176, 0
    v_mov_b32 v177, 0
    v_mov_b32 v178, 0
    v_mov_b32 v179, 0
    s_mov_b32 s30, 10
    s_lshl_b32 s29, s3, 10
    v_add_u32 v242, s29, v1
    v_add_u32 v243, 49152, v242
    v_add_u32 v244, 98304, v242
    ds_read_b128 v[44:47], v242 offset:0
    ds_read_b128 v[48:51], v242 offset:24576
    ds_read_b128 v[52:55], v243 offset:0
    ds_read_b128 v[56:59], v243 offset:24576
    ds_read_b128 v[60:63], v244 offset:0
    ds_read_b128 v[64:67], v242 offset:4096
    ds_read_b128 v[68:71], v242 offset:28672
    ds_read_b128 v[72:75], v243 offset:4096
    ds_read_b128 v[76:79], v243 offset:28672
    ds_read_b128 v[80:83], v244 offset:4096
    s_waitcnt lgkmcnt(5)
    v_mfma_f32_32x32x16_bf16 v[84:99], v[52:55], v[44:47], v[84:99]
    v_mfma_f32_32x32x16_bf16 v[132:147], v[52:55], v[48:51], v[132:147]
    v_mfma_f32_32x32x16_bf16 v[100:115], v[56:59], v[44:47], v[100:115]
    v_mfma_f32_32x32x16_bf16 v[148:163], v[56:59], v[48:51], v[148:163]
    v_mfma_f32_32x32x16_bf16 v[116:131], v[60:63], v[44:47], v[116:131]
    v_mfma_f32_32x32x16_bf16 v[164:179], v[60:63], v[48:51], v[164:179]
    ds_read_b128 v[44:47], v242 offset:8192
    ds_read_b128 v[48:51], v242 offset:32768
    ds_read_b128 v[52:55], v243 offset:8192
    ds_read_b128 v[56:59], v243 offset:32768
    ds_read_b128 v[60:63], v244 offset:8192
    s_waitcnt lgkmcnt(5)
    v_mfma_f32_32x32x16_bf16 v[84:99], v[72:75], v[64:67], v[84:99]
    v_mfma_f32_32x32x16_bf16 v[132:147], v[72:75], v[68:71], v[132:147]
    v_mfma_f32_32x32x16_bf16 v[100:115], v[76:79], v[64:67], v[100:115]
    v_mfma_f32_32x32x16_bf16 v[148:163], v[76:79], v[68:71], v[148:163]
    v_mfma_f32_32x32x16_bf16 v[116:131], v[80:83], v[64:67], v[116:131]
    v_mfma_f32_32x32x16_bf16 v[164:179], v[80:83], v[68:71], v[164:179]
    ds_read_b128 v[64:67], v242 offset:12288
    ds_read_b128 v[68:71], v242 offset:36864
    ds_read_b128 v[72:75], v243 offset:12288
    ds_read_b128 v[76:79], v243 offset:36864
    ds_read_b128 v[80:83], v244 offset:12288
    s_waitcnt lgkmcnt(5)
    v_mfma_f32_32x32x16_bf16 v[84:99], v[52:55], v[44:47], v[84:99]
    v_mfma_f32_32x32x16_bf16 v[132:147], v[52:55], v[48:51], v[132:147]
    v_mfma_f32_32x32x16_bf16 v[100:115], v[56:59], v[44:47], v[100:115]
    v_mfma_f32_32x32x16_bf16 v[148:163], v[56:59], v[48:51], v[148:163]
    v_mfma_f32_32x32x16_bf16 v[116:131], v[60:63], v[44:47], v[116:131]
    v_mfma_f32_32x32x16_bf16 v[164:179], v[60:63], v[48:51], v[164:179]
    ds_read_b128 v[44:47], v242 offset:16384
    ds_read_b128 v[48:51], v242 offset:40960
    ds_read_b128 v[52:55], v243 offset:16384
    ds_read_b128 v[56:59], v243 offset:40960
    ds_read_b128 v[60:63], v244 offset:16384
    s_waitcnt lgkmcnt(5)
    v_mfma_f32_32x32x16_bf16 v[84:99], v[72:75], v[64:67], v[84:99]
    v_mfma_f32_32x32x16_bf16 v[132:147], v[72:75], v[68:71], v[132:147]
    v_mfma_f32_32x32x16_bf16 v[100:115], v[76:79], v[64:67], v[100:115]
    v_mfma_f32_32x32x16_bf16 v[148:163], v[76:79], v[68:71], v[148:163]
    v_mfma_f32_32x32x16_bf16 v[116:131], v[80:83], v[64:67], v[116:131]
    v_mfma_f32_32x32x16_bf16 v[164:179], v[80:83], v[68:71], v[164:179]
    ds_read_b128 v[64:67], v242 offset:20480
    ds_read_b128 v[68:71], v242 offset:45056
    ds_read_b128 v[72:75], v243 offset:20480
    ds_read_b128 v[76:79], v243 offset:45056
    ds_read_b128 v[80:83], v244 offset:20480
    s_waitcnt lgkmcnt(5)
    v_mfma_f32_32x32x16_bf16 v[84:99], v[52:55], v[44:47], v[84:99]
    v_mfma_f32_32x32x16_bf16 v[132:147], v[52:55], v[48:51], v[132:147]
    v_mfma_f32_32x32x16_bf16 v[100:115], v[56:59], v[44:47], v[100:115]
    v_mfma_f32_32x32x16_bf16 v[148:163], v[56:59], v[48:51], v[148:163]
    v_mfma_f32_32x32x16_bf16 v[116:131], v[60:63], v[44:47], v[116:131]
    v_mfma_f32_32x32x16_bf16 v[164:179], v[60:63], v[48:51], v[164:179]
    buffer_load_dwordx4 v[44:47], v1, s[8:11], s26 offen sc1
    buffer_load_dwordx4 v[48:51], v2, s[8:11], s26 offen sc1
    buffer_load_dwordx4 v[52:55], v1, s[8:11], s27 offen sc1
    buffer_load_dwordx4 v[56:59], v2, s[8:11], s27 offen sc1
    buffer_load_dwordx4 v[60:63], v3, s[8:11], s27 offen sc1
    s_add_u32 s26, s26, 4096
    s_add_u32 s27, s27, 4096
    s_waitcnt lgkmcnt(0)
    v_mfma_f32_32x32x16_bf16 v[84:99], v[72:75], v[64:67], v[84:99]
    v_mfma_f32_32x32x16_bf16 v[132:147], v[72:75], v[68:71], v[132:147]
    v_mfma_f32_32x32x16_bf16 v[100:115], v[76:79], v[64:67], v[100:115]
    v_mfma_f32_32x32x16_bf16 v[148:163], v[76:79], v[68:71], v[148:163]
    v_mfma_f32_32x32x16_bf16 v[116:131], v[80:83], v[64:67], v[116:131]
    v_mfma_f32_32x32x16_bf16 v[164:179], v[80:83], v[68:71], v[164:179]
    buffer_load_dwordx4 v[64:67], v1, s[8:11], s26 offen sc1
    buffer_load_dwordx4 v[68:71], v2, s[8:11], s26 offen sc1
    buffer_load_dwordx4 v[72:75], v1, s[8:11], s27 offen sc1
    buffer_load_dwordx4 v[76:79], v2, s[8:11], s27 offen sc1
    buffer_load_dwordx4 v[80:83], v3, s[8:11], s27 offen sc1
    s_add_u32 s26, s26, 4096
    s_add_u32 s27, s27, 4096
.p2align 3
parallel_sum__softmax_full_mha__glu_gated_reglu__prompt_kernel_o_loop:
    s_cmp_lg_u32 s28, 6
    s_cbranch_scc1 parallel_sum__softmax_full_mha__glu_gated_reglu__prompt_kernel_o_nosigy
    s_barrier
    s_cmp_lg_u32 s3, 0
    s_cbranch_scc1 parallel_sum__softmax_full_mha__glu_gated_reglu__prompt_kernel_o_nosigy
    s_lshl_b32 s29, s38, 7
    s_add_u32 s29, s29, 20004864
    v_mov_b32 v242, s50
    v_mov_b32 v243, s51
    v_mov_b32 v6, 0
    s_mov_b64 exec, 1
    buffer_store_dwordx2 v[242:243], v6, s[40:43], s29 offen sc1
    s_mov_b64 exec, -1
parallel_sum__softmax_full_mha__glu_gated_reglu__prompt_kernel_o_nosigy:
    s_cmp_lg_u32 s28, 18
    s_cbranch_scc1 parallel_sum__softmax_full_mha__glu_gated_reglu__prompt_kernel_o_nopoll
    s_mov_b32 s37, 0
    s_add_u32 s29, s36, 20004864
parallel_sum__softmax_full_mha__glu_gated_reglu__prompt_kernel_o_poll:
    buffer_load_dwordx2 v[242:243], v11, s[40:43], s29 offen sc1
    s_waitcnt vmcnt(0)
    v_xor_b32 v242, s50, v242
    v_xor_b32 v243, s51, v243
    v_or_b32 v242, v242, v243
    v_cmp_ne_u32 vcc, 0, v242
    s_add_u32 s37, s37, 1
    s_cmp_ge_u32 s37, 2097152
    s_cbranch_scc1 parallel_sum__softmax_full_mha__glu_gated_reglu__prompt_kernel_o_poll_x
    s_nop 1
    s_cbranch_vccnz parallel_sum__softmax_full_mha__glu_gated_reglu__prompt_kernel_o_poll
parallel_sum__softmax_full_mha__glu_gated_reglu__prompt_kernel_o_poll_x:
parallel_sum__softmax_full_mha__glu_gated_reglu__prompt_kernel_o_nopoll:
    s_waitcnt vmcnt(10)
    v_mfma_f32_32x32x16_bf16 v[84:99], v[32:35], v[24:27], v[84:99]
    v_mfma_f32_32x32x16_bf16 v[132:147], v[32:35], v[28:31], v[132:147]
    v_mfma_f32_32x32x16_bf16 v[100:115], v[36:39], v[24:27], v[100:115]
    v_mfma_f32_32x32x16_bf16 v[148:163], v[36:39], v[28:31], v[148:163]
    v_mfma_f32_32x32x16_bf16 v[116:131], v[40:43], v[24:27], v[116:131]
    v_mfma_f32_32x32x16_bf16 v[164:179], v[40:43], v[28:31], v[164:179]
    s_cmp_eq_u32 s28, 18
    s_cselect_b32 s29, 139264, 0
    s_sub_u32 s26, s26, s29
    s_sub_u32 s27, s27, s29
    s_cmp_ge_u32 s28, 28
    s_cselect_b32 s10, 0, s10
    s_add_u32 s28, s28, 1
    buffer_load_dwordx4 v[24:27], v1, s[8:11], s26 offen sc1
    buffer_load_dwordx4 v[28:31], v2, s[8:11], s26 offen sc1
    buffer_load_dwordx4 v[32:35], v1, s[8:11], s27 offen sc1
    buffer_load_dwordx4 v[36:39], v2, s[8:11], s27 offen sc1
    buffer_load_dwordx4 v[40:43], v3, s[8:11], s27 offen sc1
    s_add_u32 s26, s26, 4096
    s_add_u32 s27, s27, 4096
    s_waitcnt vmcnt(10)
    v_mfma_f32_32x32x16_bf16 v[84:99], v[52:55], v[44:47], v[84:99]
    v_mfma_f32_32x32x16_bf16 v[132:147], v[52:55], v[48:51], v[132:147]
    v_mfma_f32_32x32x16_bf16 v[100:115], v[56:59], v[44:47], v[100:115]
    v_mfma_f32_32x32x16_bf16 v[148:163], v[56:59], v[48:51], v[148:163]
    v_mfma_f32_32x32x16_bf16 v[116:131], v[60:63], v[44:47], v[116:131]
    v_mfma_f32_32x32x16_bf16 v[164:179], v[60:63], v[48:51], v[164:179]
    s_cmp_ge_u32 s28, 28
    s_cselect_b32 s10, 0, s10
    s_add_u32 s28, s28, 1
    buffer_load_dwordx4 v[44:47], v1, s[8:11], s26 offen sc1
    buffer_load_dwordx4 v[48:51], v2, s[8:11], s26 offen sc1
    buffer_load_dwordx4 v[52:55], v1, s[8:11], s27 offen sc1
    buffer_load_dwordx4 v[56:59], v2, s[8:11], s27 offen sc1
    buffer_load_dwordx4 v[60:63], v3, s[8:11], s27 offen sc1
    s_add_u32 s26, s26, 4096
    s_add_u32 s27, s27, 4096
    s_waitcnt vmcnt(10)
    v_mfma_f32_32x32x16_bf16 v[84:99], v[72:75], v[64:67], v[84:99]
    v_mfma_f32_32x32x16_bf16 v[132:147], v[72:75], v[68:71], v[132:147]
    v_mfma_f32_32x32x16_bf16 v[100:115], v[76:79], v[64:67], v[100:115]
    v_mfma_f32_32x32x16_bf16 v[148:163], v[76:79], v[68:71], v[148:163]
    v_mfma_f32_32x32x16_bf16 v[116:131], v[80:83], v[64:67], v[116:131]
    v_mfma_f32_32x32x16_bf16 v[164:179], v[80:83], v[68:71], v[164:179]
    s_cmp_ge_u32 s28, 28
    s_cselect_b32 s10, 0, s10
    s_add_u32 s28, s28, 1
    buffer_load_dwordx4 v[64:67], v1, s[8:11], s26 offen sc1
    buffer_load_dwordx4 v[68:71], v2, s[8:11], s26 offen sc1
    buffer_load_dwordx4 v[72:75], v1, s[8:11], s27 offen sc1
    buffer_load_dwordx4 v[76:79], v2, s[8:11], s27 offen sc1
    buffer_load_dwordx4 v[80:83], v3, s[8:11], s27 offen sc1
    s_add_u32 s26, s26, 4096
    s_add_u32 s27, s27, 4096
    s_sub_u32 s30, s30, 1
    s_cmp_lg_u32 s30, 0
    s_cbranch_scc1 parallel_sum__softmax_full_mha__glu_gated_reglu__prompt_kernel_o_loop
    ds_write_b128 v4, v[84:87] offset:0
    ds_write_b128 v4, v[88:91] offset:32
    ds_write_b128 v4, v[92:95] offset:64
    ds_write_b128 v4, v[96:99] offset:96
    ds_write_b128 v4, v[100:103] offset:128
    ds_write_b128 v4, v[104:107] offset:160
    ds_write_b128 v4, v[108:111] offset:192
    ds_write_b128 v4, v[112:115] offset:224
    ds_write_b128 v4, v[116:119] offset:256
    ds_write_b128 v4, v[120:123] offset:288
    ds_write_b128 v4, v[124:127] offset:320
    ds_write_b128 v4, v[128:131] offset:352
    ds_write_b128 v4, v[132:135] offset:12800
    ds_write_b128 v4, v[136:139] offset:12832
    ds_write_b128 v4, v[140:143] offset:12864
    ds_write_b128 v4, v[144:147] offset:12896
    ds_write_b128 v4, v[148:151] offset:12928
    ds_write_b128 v4, v[152:155] offset:12960
    ds_write_b128 v4, v[156:159] offset:12992
    ds_write_b128 v4, v[160:163] offset:13024
    ds_write_b128 v4, v[164:167] offset:13056
    ds_write_b128 v4, v[168:171] offset:13088
    ds_write_b128 v4, v[172:175] offset:13120
    ds_write_b128 v4, v[176:179] offset:13152
    v_add_u32 v5, 51200, v7
    s_waitcnt vmcnt(0) lgkmcnt(0)
    s_barrier
    ds_read_b128 v[24:27], v7 offset:0
    ds_read_b128 v[28:31], v7 offset:16
    ds_read_b128 v[32:35], v7 offset:32
    ds_read_b128 v[36:39], v7 offset:48
    ds_read_b128 v[40:43], v7 offset:64
    ds_read_b128 v[44:47], v7 offset:80
    ds_read_b128 v[48:51], v7 offset:25600
    ds_read_b128 v[52:55], v7 offset:25616
    ds_read_b128 v[56:59], v7 offset:25632
    ds_read_b128 v[60:63], v7 offset:25648
    ds_read_b128 v[64:67], v7 offset:25664
    ds_read_b128 v[68:71], v7 offset:25680
    s_waitcnt lgkmcnt(6)
    ds_read_b128 v[72:75], v5 offset:0
    ds_read_b128 v[76:79], v5 offset:16
    ds_read_b128 v[80:83], v5 offset:32
    ds_read_b128 v[84:87], v5 offset:48
    ds_read_b128 v[88:91], v5 offset:64
    ds_read_b128 v[92:95], v5 offset:80
    ds_read_b128 v[96:99], v5 offset:25600
    ds_read_b128 v[100:103], v5 offset:25616
    ds_read_b128 v[104:107], v5 offset:25632
    ds_read_b128 v[108:111], v5 offset:25648
    ds_read_b128 v[112:115], v5 offset:25664
    ds_read_b128 v[116:119], v5 offset:25680
    v_lshlrev_b32 v120, 16, v12
    v_and_b32 v121, 0xffff0000, v12
    v_lshlrev_b32 v122, 16, v13
    v_and_b32 v123, 0xffff0000, v13
    v_lshlrev_b32 v124, 16, v14
    v_and_b32 v125, 0xffff0000, v14
    v_lshlrev_b32 v126, 16, v15
    v_and_b32 v127, 0xffff0000, v15
    v_lshlrev_b32 v128, 16, v16
    v_and_b32 v129, 0xffff0000, v16
    v_lshlrev_b32 v130, 16, v17
    v_and_b32 v131, 0xffff0000, v17
    v_lshlrev_b32 v132, 16, v18
    v_and_b32 v133, 0xffff0000, v18
    v_lshlrev_b32 v134, 16, v19
    v_and_b32 v135, 0xffff0000, v19
    v_lshlrev_b32 v136, 16, v20
    v_and_b32 v137, 0xffff0000, v20
    v_lshlrev_b32 v138, 16, v21
    v_and_b32 v139, 0xffff0000, v21
    v_lshlrev_b32 v140, 16, v22
    v_and_b32 v141, 0xffff0000, v22
    v_lshlrev_b32 v142, 16, v23
    v_and_b32 v143, 0xffff0000, v23
    s_waitcnt lgkmcnt(12)
    v_pk_add_f32 v[24:25], v[24:25], v[48:49]
    v_pk_add_f32 v[26:27], v[26:27], v[50:51]
    v_pk_add_f32 v[28:29], v[28:29], v[52:53]
    v_pk_add_f32 v[30:31], v[30:31], v[54:55]
    v_pk_add_f32 v[32:33], v[32:33], v[56:57]
    v_pk_add_f32 v[34:35], v[34:35], v[58:59]
    v_pk_add_f32 v[36:37], v[36:37], v[60:61]
    v_pk_add_f32 v[38:39], v[38:39], v[62:63]
    v_pk_add_f32 v[40:41], v[40:41], v[64:65]
    v_pk_add_f32 v[42:43], v[42:43], v[66:67]
    v_pk_add_f32 v[44:45], v[44:45], v[68:69]
    v_pk_add_f32 v[46:47], v[46:47], v[70:71]
    s_waitcnt lgkmcnt(0)
    v_pk_add_f32 v[72:73], v[72:73], v[96:97]
    v_pk_add_f32 v[74:75], v[74:75], v[98:99]
    v_pk_add_f32 v[76:77], v[76:77], v[100:101]
    v_pk_add_f32 v[78:79], v[78:79], v[102:103]
    v_pk_add_f32 v[80:81], v[80:81], v[104:105]
    v_pk_add_f32 v[82:83], v[82:83], v[106:107]
    v_pk_add_f32 v[84:85], v[84:85], v[108:109]
    v_pk_add_f32 v[86:87], v[86:87], v[110:111]
    v_pk_add_f32 v[88:89], v[88:89], v[112:113]
    v_pk_add_f32 v[90:91], v[90:91], v[114:115]
    v_pk_add_f32 v[92:93], v[92:93], v[116:117]
    v_pk_add_f32 v[94:95], v[94:95], v[118:119]
    v_pk_add_f32 v[24:25], v[24:25], v[72:73]
    v_pk_add_f32 v[26:27], v[26:27], v[74:75]
    v_pk_add_f32 v[28:29], v[28:29], v[76:77]
    v_pk_add_f32 v[30:31], v[30:31], v[78:79]
    v_pk_add_f32 v[32:33], v[32:33], v[80:81]
    v_pk_add_f32 v[34:35], v[34:35], v[82:83]
    v_pk_add_f32 v[36:37], v[36:37], v[84:85]
    v_pk_add_f32 v[38:39], v[38:39], v[86:87]
    v_pk_add_f32 v[40:41], v[40:41], v[88:89]
    v_pk_add_f32 v[42:43], v[42:43], v[90:91]
    v_pk_add_f32 v[44:45], v[44:45], v[92:93]
    v_pk_add_f32 v[46:47], v[46:47], v[94:95]
    v_pk_add_f32 v[24:25], v[24:25], v[120:121]
    v_pk_add_f32 v[26:27], v[26:27], v[122:123]
    v_pk_add_f32 v[28:29], v[28:29], v[124:125]
    v_pk_add_f32 v[30:31], v[30:31], v[126:127]
    v_pk_add_f32 v[32:33], v[32:33], v[128:129]
    v_pk_add_f32 v[34:35], v[34:35], v[130:131]
    v_pk_add_f32 v[36:37], v[36:37], v[132:133]
    v_pk_add_f32 v[38:39], v[38:39], v[134:135]
    v_pk_add_f32 v[40:41], v[40:41], v[136:137]
    v_pk_add_f32 v[42:43], v[42:43], v[138:139]
    v_pk_add_f32 v[44:45], v[44:45], v[140:141]
    v_pk_add_f32 v[46:47], v[46:47], v[142:143]
    v_cvt_pk_bf16_f32 v120, v24, v25
    v_cvt_pk_bf16_f32 v121, v26, v27
    v_cvt_pk_bf16_f32 v122, v28, v29
    v_cvt_pk_bf16_f32 v123, v30, v31
    v_cvt_pk_bf16_f32 v124, v32, v33
    v_cvt_pk_bf16_f32 v125, v34, v35
    v_cvt_pk_bf16_f32 v126, v36, v37
    v_cvt_pk_bf16_f32 v127, v38, v39
    v_cvt_pk_bf16_f32 v128, v40, v41
    v_cvt_pk_bf16_f32 v129, v42, v43
    v_cvt_pk_bf16_f32 v130, v44, v45
    v_cvt_pk_bf16_f32 v131, v46, v47
    buffer_store_dwordx4 v[120:123], v8, s[20:23], s4 offen
    buffer_store_dwordx4 v[124:127], v9, s[20:23], s4 offen
    buffer_store_dwordx4 v[128:131], v10, s[20:23], s4 offen
parallel_sum__softmax_full_mha__glu_gated_reglu__prompt_kernel_o_fin:
parallel_sum__softmax_full_mha__glu_gated_reglu__prompt_kernel_end:
    s_endpgm

.section .rodata,"a"
.p2align 6
.amdhsa_kernel parallel_sum__softmax_full_mha__glu_gated_reglu__prompt_kernel
  .amdhsa_next_free_vgpr 250
  .amdhsa_next_free_sgpr 75
  .amdhsa_accum_offset 252
  .amdhsa_group_segment_fixed_size 0
  .amdhsa_kernarg_size 80
  .amdhsa_user_sgpr_count 2
  .amdhsa_user_sgpr_kernarg_segment_ptr 1
  .amdhsa_system_sgpr_workgroup_id_x 1
.end_amdhsa_kernel
```
